```python
import torch

def _softmax(x, axis=-1):
    return torch.softmax(x, dim=axis)
def _gelu(x):
    return torch.nn.functional.gelu(x, approximate="tanh")
def _silu(x):
    return torch.nn.functional.silu(x)
def _sigmoid(x):
    return torch.sigmoid(x)
def _layernorm(x, axis=-1, eps=1e-5):
    m = x.mean(dim=axis, keepdim=True)
    v = x.var(dim=axis, keepdim=True, unbiased=False)
    return (x - m) / torch.sqrt(v + eps)
def _scatter_add(tgt, idx, src, axis=0):
    return tgt.clone().index_add_(axis, idx, src)
def _segment_sum(src, seg, n):
    out = torch.zeros((n,) + src.shape[1:], dtype=src.dtype)
    return out.index_add_(0, seg, src)
def _pad(x, pw):
    flat = tuple(v for pair in reversed(pw) for v in pair)
    return torch.nn.functional.pad(x, flat)

kernel_name = 'gather_scatter__edge_featured_mpnn_gatedgcn__graph'

def setup_inputs():

    _w = (lambda a: (lambda t: t.to(torch.bfloat16) if t.is_floating_point() else t)(torch.as_tensor(a)))
    N, deg, D, De = 12500, 32, 128, max(16, 1)
    E = N * deg
    return {
        "x": _w((lambda *s: torch.randn(*s, dtype=torch.bfloat16) * 0.4)(N, D)),
        "e_attr": _w((lambda *s: torch.randn(*s, dtype=torch.bfloat16) * 0.8)(E, De)),
        "src": _w((lambda lo, hi, *s: torch.randint(lo, hi, s))(0, N, E).to(torch.int64)),
        "dst": _w((lambda lo, hi, *s: torch.randint(lo, hi, s))(0, N, E).to(torch.int64)),
        "w_a": _w((lambda *s: torch.randn(*s, dtype=torch.bfloat16) * 0.4)(D, D)),
        "w_b": _w((lambda *s: torch.randn(*s, dtype=torch.bfloat16) * 0.4)(D, D)),
        "w_c": _w((lambda *s: torch.randn(*s, dtype=torch.bfloat16) * 0.8)(De, D)),
        "w_u": _w((lambda *s: torch.randn(*s, dtype=torch.bfloat16) * 0.05)(D, D)),
        "w_v": _w((lambda *s: torch.randn(*s, dtype=torch.bfloat16) * 0.05)(D, D)),
    }

def reference(x, e_attr, src, dst, w_a, w_b, w_c, w_u, w_v):
    N, D = x.shape
    hv = x @ w_v
    g = x[dst] @ w_a + x[src] @ w_b + e_attr @ w_c
    eta = _sigmoid(g)
    denom = _segment_sum(eta, dst, N) + 1e-6
    eta_n = eta / denom[dst]
    agg = _segment_sum(eta_n * hv[src], dst, N)
    z = x @ w_u + agg
    relu_z = torch.where(z > 0, z, 0 * z)
    return x + relu_z
```

```asm
; @launch grid=(256,1,1) block=(512,1,1) lds=163840
.amdgcn_target "amdgcn-amd-amdhsa--gfx950"
.text
.globl gather_scatter__edge_featured_mpnn_gatedgcn__graph_kernel
.p2align 8
.type gather_scatter__edge_featured_mpnn_gatedgcn__graph_kernel,@function
gather_scatter__edge_featured_mpnn_gatedgcn__graph_kernel:
  s_cmp_ge_u32 s2, 256
  s_cbranch_scc1 K_end
  s_load_dwordx8 s[52:59], s[0:1], 0
  s_load_dwordx16 s[64:79], s[0:1], 32
  s_getpc_b64 s[92:93]
K_pc:
  s_and_b32 s50, s2, 248
  s_lshl_b32 s50, s50, 0
  v_add_u32 v4, s50, v0
  v_mul_u32_u24 v4, (K_codeend-K_pc)/1024*4, v4
  v_cmp_gt_u32 vcc, 8, v0
  s_and_saveexec_b64 s[90:91], vcc
  s_cbranch_execz K_nocw
  global_load_dword v63, v4, s[92:93]
K_nocw:
  s_mov_b64 exec, -1
  v_lshrrev_b32 v1, 6, v0
  v_and_b32 v2, 63, v0
  v_readfirstlane_b32 s3, v1
  s_and_b32 s60, s2, 7
  s_lshr_b32 s61, s2, 3
  s_lshl_b32 s50, s60, 5
  s_add_u32 s38, s50, s61
  v_lshrrev_b32 v84, 4, v2
  v_and_b32 v85, 15, v2
  v_bfe_u32 v3, v0, 4, 4
  v_xor_b32 v3, v3, v85
  v_lshlrev_b32 v3, 4, v3
  v_lshl_add_u32 v3, v84, 8, v3
  v_lshlrev_b32 v1, 4, v0
  s_mul_i32 s8, s38, 12544
  s_lshl_b32 s90, s3, 10
  s_add_u32 s51, s8, s90
  s_add_u32 s91, s51, 8192
  s_cmp_lt_u32 s3, 5
  s_cselect_b32 s91, s91, 117440512
  s_mov_b32 s22, 3200000
  s_mov_b32 s23, 0x20000
  v_lshrrev_b32 v86, 2, v2
  v_and_b32 v87, 3, v2
  v_lshlrev_b32 v168, 4, v87
  v_lshl_add_u32 v168, v86, 8, v168
  v_mov_b32 v206, 1
  s_lshr_b32 s50, s2, 4
  s_lshl_b32 s50, s50, 3
  s_add_u32 s62, s50, s60
  s_lshr_b32 s36, s3, 2
  s_and_b32 s37, s3, 3
  s_mov_b32 s83, 0x20000
  s_mov_b32 s87, 0x20000
  s_bitcmp1_b32 s2, 3
  s_cbranch_scc1 K_np
  s_mul_i32 s88, s62, 12512
  s_add_u32 s89, s88, 8192
  s_add_u32 s82, s88, 12512
  s_min_u32 s82, s82, 1600000
  s_mov_b32 s86, s82
  s_waitcnt lgkmcnt(0)
  s_mov_b32 s80, s58
  s_mov_b32 s81, s59
  s_mov_b32 s84, s56
  s_mov_b32 s85, s57
  buffer_load_dwordx4 v[8:11], v1, s[80:83], s88 offen
  buffer_load_dwordx4 v[12:15], v1, s[80:83], s89 offen
  buffer_load_dwordx4 v[16:19], v1, s[84:87], s88 offen
  buffer_load_dwordx4 v[20:23], v1, s[84:87], s89 offen
  s_branch K_prod
K_np:
  s_or_b32 s50, s90, s2
  s_cmp_eq_u32 s50, 7176
  s_cbranch_scc1 K_clr
  s_waitcnt lgkmcnt(0)
  s_mov_b32 s20, s52
  s_mov_b32 s21, s53
  s_add_u32 m0, s90, 48128
  s_sub_u32 s50, s51, 12544
  buffer_load_dwordx4 v3, s[20:23], s50 offen lds
  s_add_u32 m0, s90, 56320
  s_sub_u32 s50, s91, 12544
  buffer_load_dwordx4 v3, s[20:23], s50 offen lds
  s_add_u32 m0, s90, 81920
  s_sub_u32 s50, s51, 0
  buffer_load_dwordx4 v3, s[20:23], s50 offen lds
  s_add_u32 m0, s90, 90112
  s_sub_u32 s50, s91, 0
  buffer_load_dwordx4 v3, s[20:23], s50 offen lds
K_np1:
  s_lshl_b32 s39, s3, 13
  s_add_u32 s39, s39, 98304
  s_lshl_b32 s63, s37, 6
  s_cmp_eq_u32 s36, 0
  s_cselect_b32 s64, s64, s70
  s_cselect_b32 s65, s65, s71
  s_cselect_b32 s66, s66, s72
  s_cselect_b32 s67, s67, s73
  s_mov_b32 s24, s66
  s_mov_b32 s25, s67
  s_mov_b32 s26, 32768
  s_mov_b32 s27, 0x20000
  s_barrier
  s_add_u32 m0, s39, 0
  s_add_u32 s89, s63, 0
  buffer_load_dwordx4 v168, s[24:27], s89 offen lds
  s_add_u32 m0, s39, 1024
  s_add_u32 s89, s63, 4096
  buffer_load_dwordx4 v168, s[24:27], s89 offen lds
  s_add_u32 m0, s39, 2048
  s_add_u32 s89, s63, 8192
  buffer_load_dwordx4 v168, s[24:27], s89 offen lds
  v_lshlrev_b32 v76, 2, v0
  v_mov_b32 v77, 0
  ds_write_b32 v76, v77
  v_mov_b32 v76, 0x6e4007ff
  v_mov_b32 v77, 117440512
  v_mov_b32 v78, v76
  v_mov_b32 v79, v77
  v_lshlrev_b32 v80, 4, v0
  ds_write_b128 v80, v[76:79] offset:7168
  ds_write_b128 v80, v[76:79] offset:15360
  ds_write_b128 v80, v[76:79] offset:23552
  ds_write_b128 v80, v[76:79] offset:31744
  ds_write_b128 v80, v[76:79] offset:39936
  s_mov_b32 s32, s68
  s_mov_b32 s33, s69
  s_mov_b32 s34, 4096
  s_mov_b32 s35, 0x20000
  s_mov_b32 s14, 20971520
  s_mov_b32 s15, 0x20000
  s_movk_i32 s30, 256
  s_mov_b32 s31, 0x20000
  s_mov_b32 s4, s78
  s_mov_b32 s5, s79
  s_mov_b32 s12, s78
  s_mov_b32 s13, s79
  s_mov_b32 s10, s74
  s_mov_b32 s11, s75
  s_mov_b32 s28, s76
  s_mov_b32 s29, s77
  v_lshrrev_b32 v88, 5, v2
  v_and_b32 v89, 31, v2
  v_lshrrev_b32 v90, 2, v85
  v_lshl_add_u32 v90, v88, 3, v90
  v_and_b32 v91, 1, v84
  v_lshlrev_b32 v91, 5, v91
  v_lshl_add_u32 v91, v87, 3, v91
  v_lshl_add_u32 v90, v90, 6, v91
  v_add_u32 v169, s39, v90
  s_lshl_b32 s50, s37, 10
  s_add_u32 s50, s50, 77824
  v_add_u32 v164, s50, v90
  v_xor_b32 v90, v88, v85
  v_lshlrev_b32 v90, 4, v90
  v_lshl_add_u32 v170, v89, 8, v90
  s_or_b32 s50, s90, s2
  s_cmp_eq_u32 s50, 7176
  s_cbranch_scc1 K_pub
  s_waitcnt vmcnt(3)
K_np2:
  s_barrier
  v_xor_b32 v3, 0, v170
  ds_read_b128 v[100:103], v3 offset:48128
  ds_read_b128 v[104:107], v3 offset:56320
  v_xor_b32 v3, 32, v170
  ds_read_b128 v[108:111], v3 offset:48128
  ds_read_b128 v[112:115], v3 offset:56320
  v_xor_b32 v3, 64, v170
  ds_read_b128 v[116:119], v3 offset:48128
  ds_read_b128 v[120:123], v3 offset:56320
  v_xor_b32 v3, 96, v170
  ds_read_b128 v[124:127], v3 offset:48128
  ds_read_b128 v[128:131], v3 offset:56320
  s_add_u32 m0, s39, 3072
  s_add_u32 s89, s63, 12288
  buffer_load_dwordx4 v168, s[24:27], s89 offen lds
  s_add_u32 m0, s39, 4096
  s_add_u32 s89, s63, 16384
  buffer_load_dwordx4 v168, s[24:27], s89 offen lds
  s_waitcnt vmcnt(4)
  ds_read_b64_tr_b16 v[208:209], v169 offset:0
  ds_read_b64_tr_b16 v[210:211], v169 offset:256
  s_waitcnt vmcnt(3)
  ds_read_b64_tr_b16 v[212:213], v169 offset:1024
  ds_read_b64_tr_b16 v[214:215], v169 offset:1280
  s_waitcnt lgkmcnt(2)
  v_mfma_f32_32x32x16_bf16 v[4:19], v[208:211], v[100:103], 0
  s_add_u32 m0, s39, 5120
  s_add_u32 s89, s63, 20480
  buffer_load_dwordx4 v168, s[24:27], s89 offen lds
  v_xor_b32 v3, 128, v170
  ds_read_b128 v[132:135], v3 offset:48128
  ds_read_b128 v[136:139], v3 offset:56320
  s_waitcnt vmcnt(3)
  ds_read_b64_tr_b16 v[216:217], v169 offset:2048
  ds_read_b64_tr_b16 v[218:219], v169 offset:2304
  v_mfma_f32_32x32x16_bf16 v[20:35], v[208:211], v[104:107], 0
  v_lshlrev_b32 v93, 3, v88
  v_lshrrev_b32 v94, 4, v0
  v_xor_b32 v90, v94, v0
  v_and_b32 v90, 15, v90
  v_lshlrev_b32 v90, 4, v90
  v_lshl_add_u32 v191, v94, 8, v90
  s_mov_b32 s94, 0xbfb8aa3b
  s_waitcnt lgkmcnt(4)
  v_mfma_f32_32x32x16_bf16 v[4:19], v[212:215], v[108:111], v[4:19]
  s_add_u32 m0, s39, 6144
  s_add_u32 s89, s63, 24576
  buffer_load_dwordx4 v168, s[24:27], s89 offen lds
  v_xor_b32 v3, 160, v170
  ds_read_b128 v[140:143], v3 offset:48128
  ds_read_b128 v[144:147], v3 offset:56320
  s_waitcnt vmcnt(3)
  ds_read_b64_tr_b16 v[220:221], v169 offset:3072
  ds_read_b64_tr_b16 v[222:223], v169 offset:3328
  v_mfma_f32_32x32x16_bf16 v[20:35], v[212:215], v[112:115], v[20:35]
  s_mov_b32 s95, 0xbfb8aa3b
  s_lshr_b32 s50, s62, 2
  s_lshl_b32 s50, s50, 7
  s_and_b32 s97, s2, 3
  s_lshl_b32 s97, s97, 2
  s_add_u32 s97, s97, s50
  s_cmp_eq_u32 s3, 0
  s_cselect_b32 s97, s97, 117440512
  s_cselect_b32 s6, 0, 117440512
  s_waitcnt lgkmcnt(4)
  v_mfma_f32_32x32x16_bf16 v[4:19], v[216:219], v[116:119], v[4:19]
  s_add_u32 m0, s39, 7168
  s_add_u32 s89, s63, 28672
  buffer_load_dwordx4 v168, s[24:27], s89 offen lds
  v_xor_b32 v3, 192, v170
  ds_read_b128 v[148:151], v3 offset:48128
  ds_read_b128 v[152:155], v3 offset:56320
  s_waitcnt vmcnt(3)
  ds_read_b64_tr_b16 v[224:225], v169 offset:4096
  ds_read_b64_tr_b16 v[226:227], v169 offset:4352
  v_mfma_f32_32x32x16_bf16 v[20:35], v[216:219], v[120:123], v[20:35]
  s_add_u32 s97, s97, 10485760
  s_lshl_b32 s50, s37, 3
  s_lshl_b32 s51, s36, 2
  s_add_u32 s50, s50, s51
  v_and_b32 v90, 7, v2
  v_xor_b32 v90, s50, v90
  v_lshl_add_u32 v90, v90, 4, v93
  s_waitcnt lgkmcnt(4)
  v_mfma_f32_32x32x16_bf16 v[4:19], v[220:223], v[124:127], v[4:19]
  s_lshl_b32 s89, s37, 10
  s_add_u32 m0, s89, 77824
  s_nop 0
  buffer_load_dwordx4 v168, s[32:35], s63 offen lds
  s_mov_b32 s24, s64
  s_mov_b32 s25, s65
  v_xor_b32 v3, 224, v170
  ds_read_b128 v[156:159], v3 offset:48128
  ds_read_b128 v[160:163], v3 offset:56320
  s_waitcnt vmcnt(3)
  ds_read_b64_tr_b16 v[228:229], v169 offset:5120
  ds_read_b64_tr_b16 v[230:231], v169 offset:5376
  v_mfma_f32_32x32x16_bf16 v[20:35], v[220:223], v[128:131], v[20:35]
  v_lshl_add_u32 v90, v89, 9, v90
  v_and_b32 v98, 8, v2
  v_xor_b32 v90, v90, v98
  v_add_u32 v171, 48128, v90
  v_bfe_u32 v90, v0, 5, 3
  v_lshlrev_b32 v90, 4, v90
  v_xor_b32 v90, v90, v1
  s_waitcnt lgkmcnt(4)
  v_mfma_f32_32x32x16_bf16 v[4:19], v[224:227], v[132:135], v[4:19]
  s_add_u32 m0, s39, 0
  s_add_u32 s89, s63, 0
  buffer_load_dwordx4 v168, s[24:27], s89 offen lds
  v_add_u32 v170, 81920, v170
  v_xor_b32 v3, 0, v170
  ds_read_b128 v[100:103], v3 offset:0
  ds_read_b128 v[104:107], v3 offset:8192
  s_waitcnt vmcnt(3)
  ds_read_b64_tr_b16 v[232:233], v169 offset:6144
  ds_read_b64_tr_b16 v[234:235], v169 offset:6400
  v_mfma_f32_32x32x16_bf16 v[20:35], v[224:227], v[136:139], v[20:35]
  v_add_u32 v172, 48128, v90
  s_lshl_b32 s50, s36, 3
  v_xor_b32 v175, s50, v172
  v_xor_b32 v204, 8, v175
  v_xor_b32 v95, 16, v171
  v_xor_b32 v96, 32, v171
  s_waitcnt lgkmcnt(4)
  v_mfma_f32_32x32x16_bf16 v[4:19], v[228:231], v[140:143], v[4:19]
  s_add_u32 m0, s39, 1024
  s_add_u32 s89, s63, 4096
  buffer_load_dwordx4 v168, s[24:27], s89 offen lds
  v_xor_b32 v3, 32, v170
  ds_read_b128 v[108:111], v3 offset:0
  ds_read_b128 v[112:115], v3 offset:8192
  s_waitcnt vmcnt(3)
  ds_read_b64_tr_b16 v[236:237], v169 offset:7168
  ds_read_b64_tr_b16 v[238:239], v169 offset:7424
  v_mfma_f32_32x32x16_bf16 v[20:35], v[228:231], v[144:147], v[20:35]
  v_xor_b32 v97, 48, v171
  s_mul_i32 s50, s38, 49
  v_lshrrev_b32 v90, 5, v0
  v_add_u32 v90, s50, v90
  v_and_b32 v98, 7, v90
  v_lshrrev_b32 v174, 3, v90
  s_waitcnt lgkmcnt(4)
  v_mfma_f32_32x32x16_bf16 v[4:19], v[232:235], v[148:151], v[4:19]
  s_add_u32 m0, s39, 2048
  s_add_u32 s89, s63, 8192
  buffer_load_dwordx4 v168, s[24:27], s89 offen lds
  v_xor_b32 v3, 64, v170
  ds_read_b128 v[116:119], v3 offset:0
  ds_read_b128 v[120:123], v3 offset:8192
  v_mfma_f32_32x32x16_bf16 v[20:35], v[232:235], v[152:155], v[20:35]
  v_lshl_or_b32 v174, v98, 11, v174
  v_lshl_add_u32 v174, v174, 5, v89
  v_lshlrev_b32 v174, 4, v174
  v_add_u32 v90, 4294967247, v90
  v_and_b32 v98, 7, v90
  v_lshrrev_b32 v173, 3, v90
  s_waitcnt lgkmcnt(2)
  v_mfma_f32_32x32x16_bf16 v[4:19], v[236:239], v[156:159], v[4:19]
  s_add_u32 m0, s39, 3072
  s_add_u32 s89, s63, 12288
  buffer_load_dwordx4 v168, s[24:27], s89 offen lds
  v_xor_b32 v3, 96, v170
  ds_read_b128 v[124:127], v3 offset:0
  ds_read_b128 v[128:131], v3 offset:8192
  v_mfma_f32_32x32x16_bf16 v[20:35], v[236:239], v[160:163], v[20:35]
  v_lshl_or_b32 v173, v98, 11, v173
  v_lshl_add_u32 v173, v173, 5, v89
  v_lshlrev_b32 v173, 4, v173
  v_cmp_gt_u32 s[56:57], 17, v89
  s_cmp_eq_u32 s36, 0
  s_cselect_b32 s96, s94, 1.0
  s_waitcnt vmcnt(4)
  ds_read_b64_tr_b16 v[166:167], v164 offset:256
  ds_read_b64_tr_b16 v[164:165], v164
  s_waitcnt lgkmcnt(0)
  s_barrier
  v_mfma_f32_32x32x16_bf16 v[36:51], v[208:211], v[100:103], 0
  v_xor_b32 v3, 128, v170
  ds_read_b128 v[132:135], v3 offset:0
  ds_read_b128 v[136:139], v3 offset:8192
  v_xor_b32 v3, 160, v170
  ds_read_b128 v[140:143], v3 offset:0
  ds_read_b128 v[144:147], v3 offset:8192
  s_add_u32 m0, s39, 4096
  s_add_u32 s89, s63, 16384
  buffer_load_dwordx4 v168, s[24:27], s89 offen lds
  v_mfma_f32_32x32x16_bf16 v[52:67], v[208:211], v[104:107], 0
  v_xor_b32 v3, 192, v170
  ds_read_b128 v[148:151], v3 offset:0
  ds_read_b128 v[152:155], v3 offset:8192
  v_xor_b32 v3, 224, v170
  ds_read_b128 v[156:159], v3 offset:0
  ds_read_b128 v[160:163], v3 offset:8192
  s_add_u32 m0, s39, 5120
  s_add_u32 s89, s63, 20480
  buffer_load_dwordx4 v168, s[24:27], s89 offen lds
  v_mfma_f32_32x32x16_bf16 v[36:51], v[212:215], v[108:111], v[36:51]
  v_add_u32 v3, 81920, v191
  ds_read_b128 v[192:195], v3
  ds_read_b128 v[196:199], v3 offset:8192
  s_add_u32 m0, s39, 6144
  s_add_u32 s89, s63, 24576
  buffer_load_dwordx4 v168, s[24:27], s89 offen lds
  v_mfma_f32_32x32x16_bf16 v[52:67], v[212:215], v[112:115], v[52:67]
  v_mul_f32 v4, s96, v4
  v_mul_f32 v5, s96, v5
  v_mul_f32 v6, s96, v6
  v_mul_f32 v7, s96, v7
  v_cvt_pk_bf16_f32 v4, v4, v5
  v_cvt_pk_bf16_f32 v5, v6, v7
  ds_write_b64 v171, v[4:5] offset:0
  s_add_u32 m0, s39, 7168
  s_add_u32 s89, s63, 28672
  buffer_load_dwordx4 v168, s[24:27], s89 offen lds
  v_mfma_f32_32x32x16_bf16 v[36:51], v[216:219], v[116:119], v[36:51]
  v_mul_f32 v8, s96, v8
  v_mul_f32 v9, s96, v9
  v_mul_f32 v10, s96, v10
  v_mul_f32 v11, s96, v11
  v_cvt_pk_bf16_f32 v8, v8, v9
  v_cvt_pk_bf16_f32 v9, v10, v11
  ds_write_b64 v95, v[8:9] offset:0
  v_mfma_f32_32x32x16_bf16 v[52:67], v[216:219], v[120:123], v[52:67]
  v_mul_f32 v12, s96, v12
  v_mul_f32 v13, s96, v13
  v_mul_f32 v14, s96, v14
  v_mul_f32 v15, s96, v15
  v_cvt_pk_bf16_f32 v12, v12, v13
  v_cvt_pk_bf16_f32 v13, v14, v15
  ds_write_b64 v96, v[12:13] offset:0
  v_mfma_f32_32x32x16_bf16 v[36:51], v[220:223], v[124:127], v[36:51]
  v_mul_f32 v16, s96, v16
  v_mul_f32 v17, s96, v17
  v_mul_f32 v18, s96, v18
  v_mul_f32 v19, s96, v19
  v_cvt_pk_bf16_f32 v16, v16, v17
  v_cvt_pk_bf16_f32 v17, v18, v19
  ds_write_b64 v97, v[16:17] offset:0
  v_mfma_f32_32x32x16_bf16 v[52:67], v[220:223], v[128:131], v[52:67]
  v_mul_f32 v20, s96, v20
  v_mul_f32 v21, s96, v21
  v_mul_f32 v22, s96, v22
  v_mul_f32 v23, s96, v23
  v_cvt_pk_bf16_f32 v20, v20, v21
  v_cvt_pk_bf16_f32 v21, v22, v23
  ds_write_b64 v171, v[20:21] offset:16384
  s_waitcnt lgkmcnt(5)
  v_mfma_f32_32x32x16_bf16 v[36:51], v[224:227], v[132:135], v[36:51]
  v_mul_f32 v24, s96, v24
  v_mul_f32 v25, s96, v25
  v_mul_f32 v26, s96, v26
  v_mul_f32 v27, s96, v27
  v_cvt_pk_bf16_f32 v24, v24, v25
  v_cvt_pk_bf16_f32 v25, v26, v27
  ds_write_b64 v95, v[24:25] offset:16384
  buffer_load_dword v99, off, s[28:31], s6 sc1
  v_mfma_f32_32x32x16_bf16 v[52:67], v[224:227], v[136:139], v[52:67]
  v_mul_f32 v28, s96, v28
  v_mul_f32 v29, s96, v29
  v_mul_f32 v30, s96, v30
  v_mul_f32 v31, s96, v31
  v_cvt_pk_bf16_f32 v28, v28, v29
  v_cvt_pk_bf16_f32 v29, v30, v31
  ds_write_b64 v96, v[28:29] offset:16384
  v_mfma_f32_32x32x16_bf16 v[36:51], v[228:231], v[140:143], v[36:51]
  v_mul_f32 v32, s96, v32
  v_mul_f32 v33, s96, v33
  v_mul_f32 v34, s96, v34
  v_mul_f32 v35, s96, v35
  v_cvt_pk_bf16_f32 v32, v32, v33
  v_cvt_pk_bf16_f32 v33, v34, v35
  ds_write_b64 v97, v[32:33] offset:16384
  v_mfma_f32_32x32x16_bf16 v[52:67], v[228:231], v[144:147], v[52:67]
  v_mfma_f32_32x32x16_bf16 v[36:51], v[232:235], v[148:151], v[36:51]
  v_mfma_f32_32x32x16_bf16 v[52:67], v[232:235], v[152:155], v[52:67]
  v_mfma_f32_32x32x16_bf16 v[36:51], v[236:239], v[156:159], v[36:51]
  v_mfma_f32_32x32x16_bf16 v[52:67], v[236:239], v[160:163], v[52:67]
  s_waitcnt lgkmcnt(0)
  s_barrier
  ds_read_b64 v[68:69], v175 offset:0
  ds_read_b64 v[70:71], v204 offset:0
  ds_read_b64 v[72:73], v175 offset:8192
  ds_read_b64 v[74:75], v204 offset:8192
  ds_read_b64 v[76:77], v175 offset:16384
  ds_read_b64 v[78:79], v204 offset:16384
  ds_read_b64 v[80:81], v175 offset:24576
  ds_read_b64 v[82:83], v204 offset:24576
  s_waitcnt lgkmcnt(6)
  buffer_store_dwordx4 v[68:71], v173, s[12:15], 0 offen offset:0 sc1
  s_waitcnt lgkmcnt(4)
  buffer_store_dwordx4 v[72:75], v173, s[12:15], 0 offen offset:1024 sc1
  s_waitcnt lgkmcnt(2)
  buffer_store_dwordx4 v[76:79], v173, s[12:15], 0 offen offset:2048 sc1
  s_mov_b32 exec_hi, 0
  s_waitcnt lgkmcnt(0)
  buffer_store_dwordx4 v[80:83], v173, s[12:15], s6 offen offset:3072 sc1
  s_mov_b32 exec_hi, -1
  s_cmp_lg_u32 s36, 0
  s_cbranch_scc1 K_ns1
  v_pk_mul_f32 v[36:37], v[36:37], s[94:95]
  v_pk_mul_f32 v[38:39], v[38:39], s[94:95]
  v_pk_mul_f32 v[40:41], v[40:41], s[94:95]
  v_pk_mul_f32 v[42:43], v[42:43], s[94:95]
  v_pk_mul_f32 v[44:45], v[44:45], s[94:95]
  v_pk_mul_f32 v[46:47], v[46:47], s[94:95]
  v_pk_mul_f32 v[48:49], v[48:49], s[94:95]
  v_pk_mul_f32 v[50:51], v[50:51], s[94:95]
  v_pk_mul_f32 v[52:53], v[52:53], s[94:95]
  v_pk_mul_f32 v[54:55], v[54:55], s[94:95]
  v_pk_mul_f32 v[56:57], v[56:57], s[94:95]
  v_pk_mul_f32 v[58:59], v[58:59], s[94:95]
  v_pk_mul_f32 v[60:61], v[60:61], s[94:95]
  v_pk_mul_f32 v[62:63], v[62:63], s[94:95]
  v_pk_mul_f32 v[64:65], v[64:65], s[94:95]
  v_pk_mul_f32 v[66:67], v[66:67], s[94:95]
K_ns1:
  v_cvt_pk_bf16_f32 v36, v36, v37
  v_cvt_pk_bf16_f32 v37, v38, v39
  ds_write_b64 v171, v[36:37] offset:25088
  v_cvt_pk_bf16_f32 v40, v40, v41
  v_cvt_pk_bf16_f32 v41, v42, v43
  ds_write_b64 v95, v[40:41] offset:25088
  v_cvt_pk_bf16_f32 v44, v44, v45
  v_cvt_pk_bf16_f32 v45, v46, v47
  ds_write_b64 v96, v[44:45] offset:25088
  v_cvt_pk_bf16_f32 v48, v48, v49
  v_cvt_pk_bf16_f32 v49, v50, v51
  ds_write_b64 v97, v[48:49] offset:25088
  s_mov_b64 exec, s[56:57]
  v_cvt_pk_bf16_f32 v52, v52, v53
  v_cvt_pk_bf16_f32 v53, v54, v55
  ds_write_b64 v171, v[52:53] offset:41472
  v_cvt_pk_bf16_f32 v56, v56, v57
  v_cvt_pk_bf16_f32 v57, v58, v59
  ds_write_b64 v95, v[56:57] offset:41472
  v_cvt_pk_bf16_f32 v60, v60, v61
  v_cvt_pk_bf16_f32 v61, v62, v63
  ds_write_b64 v96, v[60:61] offset:41472
  v_cvt_pk_bf16_f32 v64, v64, v65
  v_cvt_pk_bf16_f32 v65, v66, v67
  ds_write_b64 v97, v[64:65] offset:41472
  s_mov_b64 exec, -1
  s_waitcnt lgkmcnt(0)
  s_barrier
  ds_read_b64 v[176:177], v175 offset:25088
  ds_read_b64 v[178:179], v204 offset:25088
  ds_read_b64 v[180:181], v175 offset:33280
  ds_read_b64 v[182:183], v204 offset:33280
  ds_read_b64 v[184:185], v175 offset:41472
  ds_read_b64 v[186:187], v204 offset:41472
  ds_read_b64 v[188:189], v175 offset:49664
  ds_read_b64 v[190:191], v204 offset:49664
  s_waitcnt lgkmcnt(6)
  buffer_store_dwordx4 v[176:179], v174, s[12:15], 0 offen offset:0 sc1
  s_waitcnt lgkmcnt(4)
  buffer_store_dwordx4 v[180:183], v174, s[12:15], 0 offen offset:1024 sc1
  s_waitcnt lgkmcnt(2)
  buffer_store_dwordx4 v[184:187], v174, s[12:15], 0 offen offset:2048 sc1
  s_mov_b32 exec_hi, 0
  s_waitcnt lgkmcnt(0)
  buffer_store_dwordx4 v[188:191], v174, s[12:15], s6 offen offset:3072 sc1
  s_mov_b32 exec_hi, -1
  s_waitcnt vmcnt(8)
  ds_read_b64_tr_b16 v[208:209], v169 offset:0
  ds_read_b64_tr_b16 v[210:211], v169 offset:256
  ds_read_b64_tr_b16 v[212:213], v169 offset:1024
  ds_read_b64_tr_b16 v[214:215], v169 offset:1280
  ds_read_b64_tr_b16 v[216:217], v169 offset:2048
  ds_read_b64_tr_b16 v[218:219], v169 offset:2304
  ds_read_b64_tr_b16 v[220:221], v169 offset:3072
  ds_read_b64_tr_b16 v[222:223], v169 offset:3328
  ds_read_b64_tr_b16 v[224:225], v169 offset:4096
  ds_read_b64_tr_b16 v[226:227], v169 offset:4352
  ds_read_b64_tr_b16 v[228:229], v169 offset:5120
  ds_read_b64_tr_b16 v[230:231], v169 offset:5376
  ds_read_b64_tr_b16 v[232:233], v169 offset:6144
  ds_read_b64_tr_b16 v[234:235], v169 offset:6400
  ds_read_b64_tr_b16 v[236:237], v169 offset:7168
  ds_read_b64_tr_b16 v[238:239], v169 offset:7424
  s_waitcnt lgkmcnt(14)
  v_mfma_f32_32x32x16_bf16 v[4:19], v[208:211], v[100:103], 0
  v_mfma_f32_32x32x16_bf16 v[20:35], v[208:211], v[104:107], 0
  s_waitcnt lgkmcnt(12)
  v_mfma_f32_32x32x16_bf16 v[4:19], v[212:215], v[108:111], v[4:19]
  v_mfma_f32_32x32x16_bf16 v[20:35], v[212:215], v[112:115], v[20:35]
  s_waitcnt lgkmcnt(0)
  v_mfma_f32_32x32x16_bf16 v[4:19], v[216:219], v[116:119], v[4:19]
  v_mfma_f32_32x32x16_bf16 v[20:35], v[216:219], v[120:123], v[20:35]
  v_mfma_f32_32x32x16_bf16 v[4:19], v[220:223], v[124:127], v[4:19]
  v_mfma_f32_32x32x16_bf16 v[20:35], v[220:223], v[128:131], v[20:35]
  v_mfma_f32_32x32x16_bf16 v[4:19], v[224:227], v[132:135], v[4:19]
  v_mfma_f32_32x32x16_bf16 v[20:35], v[224:227], v[136:139], v[20:35]
  v_mfma_f32_32x32x16_bf16 v[4:19], v[228:231], v[140:143], v[4:19]
  v_mfma_f32_32x32x16_bf16 v[20:35], v[228:231], v[144:147], v[20:35]
  v_mfma_f32_32x32x16_bf16 v[4:19], v[232:235], v[148:151], v[4:19]
  v_mfma_f32_32x32x16_bf16 v[20:35], v[232:235], v[152:155], v[20:35]
  v_mfma_f32_32x32x16_bf16 v[4:19], v[236:239], v[156:159], v[4:19]
  v_mfma_f32_32x32x16_bf16 v[20:35], v[236:239], v[160:163], v[20:35]
  s_cmp_lg_u32 s3, 0
  s_cbranch_scc1 K_rn
  s_mov_b32 s50, 0
K_rn_spin:
  v_cmp_eq_u32 vcc, 0, v99
  s_cbranch_vccz K_rn
  buffer_load_dword v99, off, s[28:31], s6 sc1
  s_add_u32 s50, s50, 1
  s_cmp_lt_u32 s50, 0x40000
  s_waitcnt vmcnt(0)
  s_cbranch_scc1 K_rn_spin
K_rn:
K_join:
  v_lshlrev_b32 v171, 7, v89
  s_cmp_lg_u32 s3, 0
  s_cbranch_scc1 K_nopoll
  s_mov_b32 s50, 10489856
  buffer_load_dwordx4 v[68:71], v171, s[12:15], s50 offen sc1
K_nopoll:
  v_lshrrev_b32 v95, 2, v0
  v_lshlrev_b32 v202, 4, v87
  v_lshl_add_u32 v200, v95, 7, v202
  v_mul_u32_u24 v92, 576, v89
  v_mul_u32_u24 v203, 3128, v95
  s_lshl_b32 s44, s38, 14
  s_add_u32 s44, s44, 16777216
  s_mov_b32 s16, s54
  s_mov_b32 s17, s55
  s_mov_b32 s18, 12800000
  s_mov_b32 s19, 0x20000
  s_mov_b32 s7, 0
  s_bitcmp1_b32 s2, 3
  s_cselect_b32 s60, 8, 8
  s_cmp_lg_u32 s36, 0
  s_cbranch_scc1 K_uaddr
  v_cmp_gt_u32 s[90:91], 18, v89
  s_lshl_b32 s51, s37, 7
  s_add_u32 s51, s51, 48128
  v_add3_u32 v81, v92, v93, s51
  v_pk_mul_f32 v[4:5], v[4:5], s[94:95]
  v_pk_mul_f32 v[6:7], v[6:7], s[94:95]
  v_pk_mul_f32 v[8:9], v[8:9], s[94:95]
  v_pk_mul_f32 v[10:11], v[10:11], s[94:95]
  v_pk_mul_f32 v[12:13], v[12:13], s[94:95]
  v_pk_mul_f32 v[14:15], v[14:15], s[94:95]
  v_pk_mul_f32 v[16:17], v[16:17], s[94:95]
  v_pk_mul_f32 v[18:19], v[18:19], s[94:95]
  v_pk_mul_f32 v[20:21], v[20:21], s[94:95]
  v_pk_mul_f32 v[22:23], v[22:23], s[94:95]
  v_pk_mul_f32 v[24:25], v[24:25], s[94:95]
  v_pk_mul_f32 v[26:27], v[26:27], s[94:95]
  v_pk_mul_f32 v[28:29], v[28:29], s[94:95]
  v_pk_mul_f32 v[30:31], v[30:31], s[94:95]
  v_pk_mul_f32 v[32:33], v[32:33], s[94:95]
  v_pk_mul_f32 v[34:35], v[34:35], s[94:95]
  v_cvt_pk_bf16_f32 v4, v4, v5
  v_cvt_pk_bf16_f32 v5, v6, v7
  v_cvt_pk_bf16_f32 v8, v8, v9
  v_cvt_pk_bf16_f32 v9, v10, v11
  v_cvt_pk_bf16_f32 v12, v12, v13
  v_cvt_pk_bf16_f32 v13, v14, v15
  v_cvt_pk_bf16_f32 v16, v16, v17
  v_cvt_pk_bf16_f32 v17, v18, v19
  v_cvt_pk_bf16_f32 v20, v20, v21
  v_cvt_pk_bf16_f32 v21, v22, v23
  v_cvt_pk_bf16_f32 v24, v24, v25
  v_cvt_pk_bf16_f32 v25, v26, v27
  v_cvt_pk_bf16_f32 v28, v28, v29
  v_cvt_pk_bf16_f32 v29, v30, v31
  v_cvt_pk_bf16_f32 v32, v32, v33
  v_cvt_pk_bf16_f32 v33, v34, v35
  s_branch K_conv
K_uaddr:
  v_bfe_u32 v52, v2, 1, 2
  v_lshl_add_u32 v52, v52, 4, v93
  v_lshl_add_u32 v52, v89, 6, v52
  v_add_u32 v52, s39, v52
  v_xor_b32 v53, 16, v52
  v_xor_b32 v54, 32, v52
  v_xor_b32 v55, 48, v52
  v_cvt_pk_bf16_f32 v4, v4, v5
  v_cvt_pk_bf16_f32 v5, v6, v7
  ds_write_b64 v52, v[4:5] offset:0
  v_cvt_pk_bf16_f32 v8, v8, v9
  v_cvt_pk_bf16_f32 v9, v10, v11
  ds_write_b64 v53, v[8:9] offset:0
  v_cvt_pk_bf16_f32 v12, v12, v13
  v_cvt_pk_bf16_f32 v13, v14, v15
  ds_write_b64 v54, v[12:13] offset:0
  v_cvt_pk_bf16_f32 v16, v16, v17
  v_cvt_pk_bf16_f32 v17, v18, v19
  ds_write_b64 v55, v[16:17] offset:0
  v_cvt_pk_bf16_f32 v20, v20, v21
  v_cvt_pk_bf16_f32 v21, v22, v23
  ds_write_b64 v52, v[20:21] offset:2048
  v_cvt_pk_bf16_f32 v24, v24, v25
  v_cvt_pk_bf16_f32 v25, v26, v27
  ds_write_b64 v53, v[24:25] offset:2048
  v_cvt_pk_bf16_f32 v28, v28, v29
  v_cvt_pk_bf16_f32 v29, v30, v31
  ds_write_b64 v54, v[28:29] offset:2048
  v_cvt_pk_bf16_f32 v32, v32, v33
  v_cvt_pk_bf16_f32 v33, v34, v35
  ds_write_b64 v55, v[32:33] offset:2048
  v_and_b32 v45, 63, v95
  v_and_b32 v46, 31, v95
  v_lshlrev_b32 v47, 3, v87
  v_sub_u32 v46, v46, v47
  v_cmp_eq_u32 s[90:91], 49, v45
  v_mov_b32 v47, 64
  v_cmp_ge_u32 s[92:93], 49, v45
  v_cndmask_b32 v46, v46, v47, s[90:91]
  v_and_b32 v47, 1, v46
  v_lshlrev_b32 v47, 4, v47
  v_mov_b32 v48, 0x3f80
  v_lshlrev_b32 v47, v47, v48
  v_ashrrev_i32 v46, 1, v46
  v_cmp_eq_u32 s[64:65], 0, v46
  v_cmp_eq_u32 s[66:67], 1, v46
  v_cmp_eq_u32 s[68:69], 2, v46
  v_cmp_eq_u32 s[70:71], 3, v46
  v_cndmask_b32 v48, 0, v47, s[64:65]
  v_cndmask_b32 v49, 0, v47, s[66:67]
  v_cndmask_b32 v50, 0, v47, s[68:69]
  v_cndmask_b32 v51, 0, v47, s[70:71]
  v_mul_u32_u24 v46, 576, v45
  v_add_u32 v46, v46, v202
K_conv:
  s_cmp_lg_u32 s3, 0
  s_cbranch_scc1 K_s_done
  s_mov_b32 s50, 0
  s_mov_b32 s51, 10489856
K_s_spin:
  s_waitcnt vmcnt(0)
  v_and_b32 v68, v68, v69
  v_and_b32 v70, v70, v71
  v_and_b32 v68, v68, v70
  v_cmp_ne_u32 vcc, 1, v68
  s_cbranch_vccz K_s_done
  s_add_u32 s50, s50, 1
  s_cmp_lt_u32 s50, 0x40000
  buffer_load_dwordx4 v[68:71], v171, s[12:15], s51 offen sc1
  s_cbranch_scc1 K_s_spin
K_s_done:
  s_waitcnt vmcnt(0) lgkmcnt(0)
  s_barrier
  buffer_load_dwordx4 v[36:39], v200, s[12:15], s44 offen sc1
  buffer_load_dwordx4 v[40:43], v200, s[12:15], s44 offen offset:64 sc1
  s_mov_b64 exec, 1
  buffer_store_dword v206, off, s[12:15], s97 sc1
  s_mov_b64 exec, -1
  s_cmp_eq_u32 s36, 0
  s_cbranch_scc1 K_tab
  s_mov_b64 exec, s[92:93]
  ds_write_b128 v46, v[48:51] offset:48192
  ds_write_b128 v46, v[48:51] offset:48320
  ds_write_b128 v46, v[48:51] offset:48448
  ds_write_b128 v46, v[48:51] offset:48576
K_tab:
  s_mov_b64 exec, -1
  s_lshl_b32 s50, s37, 7
  s_add_u32 s51, s50, 48128
  v_add_u32 v190, s51, v91
  v_lshlrev_b32 v90, 2, v84
  v_xor_b32 v90, v90, v2
  v_and_b32 v90, 7, v90
  v_lshl_add_u32 v176, v90, 4, s50
  v_add_u32 v177, 0x400, v176
  v_add_u32 v182, 0x800, v176
  v_add_u32 v207, 0xc00, v176
  v_bfe_u32 v90, v0, 2, 2
  v_lshlrev_b32 v90, 13, v90
  v_lshl_add_u32 v90, v94, 6, v90
  v_bfe_u32 v96, v0, 5, 2
  v_xor_b32 v96, v96, v87
  v_lshl_add_u32 v90, v96, 4, v90
  v_add_u32 v3, 131072, v90
  ds_read_b128 v[240:243], v3
  ds_read_b128 v[244:247], v3 offset:2048
  s_lshr_b32 s51, s37, 1
  v_xor_b32 v84, s51, v2
  v_and_b32 v84, 1, v84
  v_lshlrev_b32 v179, 4, v84
  s_mov_b32 s47, 512
  s_lshl_b32 s50, s36, 12
  s_add_u32 s93, s50, 81920
  s_lshl_b32 s51, s37, 8
  s_add_u32 s40, s93, s51
  s_mul_i32 s50, s36, 20480
  s_add_u32 s50, s50, 7168
  v_and_b32 v98, 32, v2
  v_bfe_u32 v97, v2, 4, 1
  v_bfe_u32 v96, v2, 3, 1
  v_lshl_add_u32 v96, v96, 2, v97
  v_add_u32 v96, v96, v98
  v_lshl_add_u32 v185, v96, 3, s50
  v_and_b32 v96, 0x2c, v2
  v_lshl_add_u32 v187, v96, 3, s50
  v_and_b32 v96, 2, v2
  v_bfe_u32 v99, v2, 2, 1
  v_lshl_add_u32 v96, v96, 1, v99
  v_and_or_b32 v96, v2, 8, v96
  s_lshr_b32 s51, s37, 1
  s_lshl_b32 s51, s51, 7
  s_add_u32 s50, s50, s51
  s_and_b32 s51, s37, 1
  s_lshl_b32 s51, s51, 8
  s_add_u32 s50, s50, s51
  v_lshl_add_u32 v186, v96, 3, s50
  v_mov_b32 v77, 8
  v_lshlrev_b32 v76, 5, v2
  s_waitcnt vmcnt(1)
  s_movk_i32 s51, 2016
  s_movk_i32 s50, 2044
  v_lshrrev_b32 v44, 9, v36
  v_and_b32 v44, s50, v44
  v_cmp_gt_u32 s[64:65], s51, v44
  v_lshrrev_b32 v45, 9, v37
  v_and_b32 v45, s50, v45
  v_cmp_gt_u32 s[66:67], s51, v45
  v_lshrrev_b32 v46, 9, v38
  v_and_b32 v46, s50, v46
  v_cmp_gt_u32 s[68:69], s51, v46
  v_lshrrev_b32 v47, 9, v39
  v_and_b32 v47, s50, v47
  v_cmp_gt_u32 s[70:71], s51, v47
  v_lshrrev_b32 v48, 9, v40
  v_and_b32 v48, s50, v48
  v_cmp_gt_u32 s[72:73], s51, v48
  v_lshrrev_b32 v49, 9, v41
  v_and_b32 v49, s50, v49
  v_cmp_gt_u32 s[74:75], s51, v49
  v_lshrrev_b32 v50, 9, v42
  v_and_b32 v50, s50, v50
  v_cmp_gt_u32 s[76:77], s51, v50
  v_lshrrev_b32 v51, 9, v43
  v_and_b32 v51, s50, v51
  v_cmp_gt_u32 s[78:79], s51, v51
  s_mov_b64 exec, s[64:65]
  ds_add_rtn_u32 v52, v44, v77
  s_mov_b64 exec, s[66:67]
  ds_add_rtn_u32 v53, v45, v77
  s_mov_b64 exec, s[68:69]
  ds_add_rtn_u32 v54, v46, v77
  s_mov_b64 exec, s[70:71]
  ds_add_rtn_u32 v55, v47, v77
  s_mov_b64 exec, s[72:73]
  ds_add_rtn_u32 v56, v48, v77
  s_mov_b64 exec, s[74:75]
  ds_add_rtn_u32 v57, v49, v77
  s_mov_b64 exec, s[76:77]
  ds_add_rtn_u32 v58, v50, v77
  s_mov_b64 exec, s[78:79]
  ds_add_rtn_u32 v59, v51, v77
  s_mov_b64 exec, -1
  s_movk_i32 s50, 2304
  v_lshrrev_b32 v101, 20, v36
  v_add_lshl_u32 v101, v101, v203, 5
  v_lshrrev_b32 v103, 20, v37
  v_add_lshl_u32 v103, v103, v203, 5
  v_lshrrev_b32 v105, 20, v38
  v_add_lshl_u32 v105, v105, v203, 5
  v_lshrrev_b32 v107, 20, v39
  v_add_lshl_u32 v107, v107, v203, 5
  v_lshrrev_b32 v109, 20, v40
  v_add_lshl_u32 v109, v109, v203, 5
  v_lshrrev_b32 v111, 20, v41
  v_add_lshl_u32 v111, v111, v203, 5
  v_lshrrev_b32 v113, 20, v42
  v_add_lshl_u32 v113, v113, v203, 5
  v_lshrrev_b32 v115, 20, v43
  v_add_lshl_u32 v115, v115, v203, 5
  v_and_b32 v3, 28, v44
  v_cmp_gt_u32 vcc, s60, v3
  s_and_b64 exec, vcc, s[64:65]
  buffer_load_dword v201, v101, s[16:19], 0 offen
  s_mov_b64 exec, -1
  v_and_b32 v3, 28, v45
  v_cmp_gt_u32 vcc, s60, v3
  s_and_b64 exec, vcc, s[66:67]
  buffer_load_dword v201, v103, s[16:19], 0 offen
  s_mov_b64 exec, -1
  v_and_b32 v3, 28, v46
  v_cmp_gt_u32 vcc, s60, v3
  s_and_b64 exec, vcc, s[68:69]
  buffer_load_dword v201, v105, s[16:19], 0 offen
  s_mov_b64 exec, -1
  v_and_b32 v3, 28, v47
  v_cmp_gt_u32 vcc, s60, v3
  s_and_b64 exec, vcc, s[70:71]
  buffer_load_dword v201, v107, s[16:19], 0 offen
  s_mov_b64 exec, -1
  s_cmp_eq_u32 s3, 4
  s_waitcnt lgkmcnt(0)
  s_barrier
  s_cbranch_scc1 K_scana
  v_and_b32 v3, 28, v48
  v_cmp_gt_u32 vcc, s60, v3
  s_and_b64 exec, vcc, s[72:73]
  buffer_load_dword v201, v109, s[16:19], 0 offen
  s_mov_b64 exec, -1
  v_and_b32 v3, 28, v49
  v_cmp_gt_u32 vcc, s60, v3
  s_and_b64 exec, vcc, s[74:75]
  buffer_load_dword v201, v111, s[16:19], 0 offen
  s_mov_b64 exec, -1
  v_and_b32 v3, 28, v50
  v_cmp_gt_u32 vcc, s60, v3
  s_and_b64 exec, vcc, s[76:77]
  buffer_load_dword v201, v113, s[16:19], 0 offen
  s_mov_b64 exec, -1
  v_and_b32 v3, 28, v51
  v_cmp_gt_u32 vcc, s60, v3
  s_and_b64 exec, vcc, s[78:79]
  buffer_load_dword v201, v115, s[16:19], 0 offen
  s_mov_b64 exec, -1
  s_cmp_lg_u32 s36, 0
  s_cbranch_scc1 K_noa
  ds_write_b64 v81, v[4:5] offset:0
  ds_write_b64 v81, v[8:9] offset:16
  ds_write_b64 v81, v[12:13] offset:32
  ds_write_b64 v81, v[16:17] offset:48
  s_mov_b64 exec, s[90:91]
  ds_write_b64 v81, v[20:21] offset:18432
  ds_write_b64 v81, v[24:25] offset:18448
  ds_write_b64 v81, v[28:29] offset:18464
  ds_write_b64 v81, v[32:33] offset:18480
  s_mov_b64 exec, -1
K_noa:
  v_and_b32 v90, 5, v89
  v_bfe_u32 v96, v89, 3, 1
  v_lshl_add_u32 v90, v96, 1, v90
  v_lshrrev_b32 v96, 4, v89
  v_lshl_add_u32 v90, v96, 3, v90
  v_mul_u32_u24 v90, 576, v90
  v_lshl_add_u32 v3, v88, 4, v90
  ds_read_b128 v[4:7], v3 offset:48192
  v_lshrrev_b32 v90, 3, v89
  v_and_b32 v96, 1, v89
  v_lshl_add_u32 v90, v90, 1, v96
  v_and_b32 v96, 4, v89
  v_lshl_add_u32 v90, v96, 1, v90
  v_mul_u32_u24 v90, 576, v90
  v_lshl_add_u32 v3, v88, 4, v90
  ds_read_b128 v[12:15], v3 offset:48192
  v_and_b32 v100, 0x3fff, v36
  v_and_b32 v3, 0xfc000, v36
  v_mad_u32_u24 v100, v3, s50, v100
  v_and_b32 v102, 0x3fff, v37
  v_and_b32 v3, 0xfc000, v37
  v_mad_u32_u24 v102, v3, s50, v102
  v_and_b32 v104, 0x3fff, v38
  v_and_b32 v3, 0xfc000, v38
  v_mad_u32_u24 v104, v3, s50, v104
  v_and_b32 v106, 0x3fff, v39
  v_and_b32 v3, 0xfc000, v39
  v_mad_u32_u24 v106, v3, s50, v106
  v_and_b32 v108, 0x3fff, v40
  v_and_b32 v3, 0xfc000, v40
  v_mad_u32_u24 v108, v3, s50, v108
  v_and_b32 v110, 0x3fff, v41
  v_and_b32 v3, 0xfc000, v41
  v_mad_u32_u24 v110, v3, s50, v110
  v_and_b32 v112, 0x3fff, v42
  v_and_b32 v3, 0xfc000, v42
  v_mad_u32_u24 v112, v3, s50, v112
  v_and_b32 v114, 0x3fff, v43
  v_and_b32 v3, 0xfc000, v43
  v_mad_u32_u24 v114, v3, s50, v114
  s_cmp_lg_u32 s3, 7
  s_cbranch_scc1 K_scanneda
  s_mov_b32 s50, 10485760
  buffer_load_dwordx4 v[156:159], v171, s[12:15], s50 offen sc1
  s_branch K_scanneda
K_scana:
  ds_read_b128 v[116:119], v76
  ds_read_b128 v[120:123], v76 offset:16
  s_setprio 1
  v_and_b32 v100, 0x3fff, v36
  v_and_b32 v3, 0xfc000, v36
  v_mad_u32_u24 v100, v3, s50, v100
  v_and_b32 v102, 0x3fff, v37
  v_and_b32 v3, 0xfc000, v37
  v_mad_u32_u24 v102, v3, s50, v102
  v_and_b32 v104, 0x3fff, v38
  v_and_b32 v3, 0xfc000, v38
  v_mad_u32_u24 v104, v3, s50, v104
  v_and_b32 v106, 0x3fff, v39
  v_and_b32 v3, 0xfc000, v39
  v_mad_u32_u24 v106, v3, s50, v106
  v_and_b32 v108, 0x3fff, v40
  v_and_b32 v3, 0xfc000, v40
  v_mad_u32_u24 v108, v3, s50, v108
  v_and_b32 v110, 0x3fff, v41
  v_and_b32 v3, 0xfc000, v41
  v_mad_u32_u24 v110, v3, s50, v110
  v_and_b32 v112, 0x3fff, v42
  v_and_b32 v3, 0xfc000, v42
  v_mad_u32_u24 v112, v3, s50, v112
  v_and_b32 v114, 0x3fff, v43
  v_and_b32 v3, 0xfc000, v43
  v_mad_u32_u24 v114, v3, s50, v114
  s_mov_b32 s51, 0xffe0ffe0
  s_waitcnt lgkmcnt(0)
  v_readlane_b32 s46, v116, 62
  v_writelane_b32 v116, 0, 62
  v_add_u32 v117, v116, v117
  v_add_u32 v118, v117, v118
  v_add_u32 v119, v118, v119
  v_add_u32 v120, v119, v120
  v_add_u32 v121, v120, v121
  v_add_u32 v122, v121, v122
  v_add_u32 v123, v122, v123
  v_add_u32 v60, 15, v123
  v_and_b32 v60, 0xffe0, v60
  v_mov_b32 v78, v60
  v_cmp_lt_u32 s[88:89], v60, v123
  v_lshl_or_b32 v125, v117, 16, v116
  v_add_u32_dpp v78, v78, v78 row_shr:1 row_mask:0xf bank_mask:0xf
  v_lshl_or_b32 v127, v119, 16, v118
  v_lshl_or_b32 v129, v121, 16, v120
  v_add_u32_dpp v78, v78, v78 row_shr:2 row_mask:0xf bank_mask:0xf
  v_lshl_or_b32 v131, v123, 16, v122
  v_mbcnt_lo_u32_b32 v61, s88, 0
  v_add_u32_dpp v78, v78, v78 row_shr:4 row_mask:0xf bank_mask:0xf
  v_mbcnt_hi_u32_b32 v61, s89, v61
  v_sub_u32 v64, v123, v60
  v_add_u32_dpp v78, v78, v78 row_shr:8 row_mask:0xf bank_mask:0xf
  v_mov_b32 v148, 0x1e001e00
  v_mov_b32 v149, 0x6e006e00
  v_add_u32_dpp v78, v78, v78 row_bcast:15 row_mask:0xa bank_mask:0xf
  s_nop 1
  v_add_u32_dpp v78, v78, v78 row_bcast:31 row_mask:0xc bank_mask:0xf
  s_nop 1
  v_readlane_b32 s50, v78, 63
  v_sub_u32 v78, v78, v60
  v_lshlrev_b32 v79, 1, v78
  v_cmp_gt_u32 vcc, s50, v79
  v_sub_u32 v79, s50, v78
  v_add_u32 v78, 0xff, v78
  v_add_u32 v79, 0xff, v79
  s_bcnt1_i32_b64 s50, vcc
  v_lshrrev_b32 v78, 8, v78
  s_max_u32 s50, s50, 18
  v_lshrrev_b32 v79, 8, v79
  s_min_u32 s50, s50, 32
  v_lshl_add_u32 v78, v78, 1, -1
  v_lshlrev_b32 v79, 1, v79
  v_max_i32 v78, v78, v79
  s_sub_u32 s58, s50, 1
  v_readlane_b32 s56, v78, s50
  v_readlane_b32 s57, v78, s58
  s_cmp_le_i32 s56, s57
  s_cselect_b32 s43, s50, s58
  v_readlane_b32 s56, v61, s43
  v_cmp_le_u32 vcc, s43, v2
  s_nop 0
  v_subrev_u32 v78, s56, v61
  v_cndmask_b32 v80, v148, v149, vcc
  v_cndmask_b32 v61, v61, v78, vcc
  v_cmp_gt_u32 s[56:57], 16, v61
  s_and_b64 s[88:89], s[88:89], s[56:57]
  v_lshl_add_u32 v61, v61, 5, v80
  v_cndmask_b32 v63, 0, 32, s[88:89]
  v_cndmask_b32 v64, 0, v64, s[88:89]
  v_sub_u32 v62, v63, v64
  v_lshl_or_b32 v62, v62, 16, v62
  v_add_u32 v125, v62, v125
  v_add_u32 v127, v62, v127
  v_add_u32 v129, v62, v129
  v_add_u32 v131, v62, v131
  v_add_u32 v132, 0x001f001f, v125
  v_add_u32 v133, 0x001f001f, v127
  v_add_u32 v134, 0x001f001f, v129
  v_add_u32 v135, 0x001f001f, v131
  v_and_b32 v132, s51, v132
  v_and_b32 v133, s51, v133
  v_and_b32 v134, s51, v134
  v_and_b32 v135, s51, v135
  v_lshl_or_b32 v136, v132, 16, v63
  v_alignbit_b32 v137, v133, v132, 16
  v_alignbit_b32 v138, v134, v133, 16
  v_alignbit_b32 v139, v135, v134, 16
  v_sub_u32 v140, v132, v136
  v_sub_u32 v141, v133, v137
  v_sub_u32 v142, v134, v138
  v_sub_u32 v143, v135, v139
  v_add_u32_dpp v140, v140, v140 row_shr:1 row_mask:0xf bank_mask:0xf
  v_add_u32_dpp v141, v141, v141 row_shr:1 row_mask:0xf bank_mask:0xf
  v_add_u32_dpp v142, v142, v142 row_shr:1 row_mask:0xf bank_mask:0xf
  v_add_u32_dpp v143, v143, v143 row_shr:1 row_mask:0xf bank_mask:0xf
  v_add_u32_dpp v140, v140, v140 row_shr:2 row_mask:0xf bank_mask:0xf
  v_add_u32_dpp v141, v141, v141 row_shr:2 row_mask:0xf bank_mask:0xf
  v_add_u32_dpp v142, v142, v142 row_shr:2 row_mask:0xf bank_mask:0xf
  v_add_u32_dpp v143, v143, v143 row_shr:2 row_mask:0xf bank_mask:0xf
  v_add_u32_dpp v140, v140, v140 row_shr:4 row_mask:0xf bank_mask:0xf
  v_add_u32_dpp v141, v141, v141 row_shr:4 row_mask:0xf bank_mask:0xf
  v_add_u32_dpp v142, v142, v142 row_shr:4 row_mask:0xf bank_mask:0xf
  v_add_u32_dpp v143, v143, v143 row_shr:4 row_mask:0xf bank_mask:0xf
  v_add_u32_dpp v140, v140, v140 row_shr:8 row_mask:0xf bank_mask:0xf
  v_add_u32_dpp v141, v141, v141 row_shr:8 row_mask:0xf bank_mask:0xf
  v_add_u32_dpp v142, v142, v142 row_shr:8 row_mask:0xf bank_mask:0xf
  v_add_u32_dpp v143, v143, v143 row_shr:8 row_mask:0xf bank_mask:0xf
  v_add_u32_dpp v140, v140, v140 row_bcast:15 row_mask:0xa bank_mask:0xf
  v_add_u32_dpp v141, v141, v141 row_bcast:15 row_mask:0xa bank_mask:0xf
  v_add_u32_dpp v142, v142, v142 row_bcast:15 row_mask:0xa bank_mask:0xf
  v_add_u32_dpp v143, v143, v143 row_bcast:15 row_mask:0xa bank_mask:0xf
  v_add_u32_dpp v140, v140, v140 row_bcast:31 row_mask:0xc bank_mask:0xf
  v_add_u32_dpp v141, v141, v141 row_bcast:31 row_mask:0xc bank_mask:0xf
  v_add_u32_dpp v142, v142, v142 row_bcast:31 row_mask:0xc bank_mask:0xf
  v_add_u32_dpp v143, v143, v143 row_bcast:31 row_mask:0xc bank_mask:0xf
  v_sub_u32 v136, v132, v136
  v_sub_u32 v137, v133, v137
  v_sub_u32 v138, v134, v138
  v_sub_u32 v139, v135, v139
  v_sub_u32 v144, v140, v136
  v_sub_u32 v145, v141, v137
  v_sub_u32 v146, v142, v138
  v_sub_u32 v147, v143, v139
  v_readlane_b32 s84, v140, 63
  v_readlane_b32 s85, v141, 63
  v_readlane_b32 s86, v142, 63
  v_readlane_b32 s87, v143, 63
  v_readlane_b32 s80, v144, s43
  v_readlane_b32 s81, v145, s43
  v_readlane_b32 s82, v146, s43
  v_readlane_b32 s83, v147, s43
  v_sub_u32 v125, v132, v125
  v_sub_u32 v127, v133, v127
  v_sub_u32 v129, v134, v129
  v_sub_u32 v131, v135, v131
  v_mov_b32 v148, s80
  v_mov_b32 v149, s81
  v_mov_b32 v150, s82
  v_mov_b32 v151, s83
  v_sub_u32 v152, s84, v148
  v_cndmask_b32 v132, 0, v148, vcc
  v_sub_u32 v153, s85, v149
  v_cndmask_b32 v133, 0, v149, vcc
  v_sub_u32 v154, s86, v150
  v_cndmask_b32 v134, 0, v150, vcc
  v_sub_u32 v155, s87, v151
  v_cndmask_b32 v135, 0, v151, vcc
  v_cndmask_b32 v148, v148, v152, vcc
  v_cndmask_b32 v149, v149, v153, vcc
  v_cndmask_b32 v150, v150, v154, vcc
  v_cndmask_b32 v151, v151, v155, vcc
  v_add_u32 v61, 4294966816, v61
  s_mov_b32 s51, 0x03020302
  v_lshl_or_b32 v124, v125, 16, v64
  v_sub_u32 v144, v144, v132
  v_alignbit_b32 v126, v127, v125, 16
  v_sub_u32 v145, v145, v133
  v_alignbit_b32 v128, v129, v127, 16
  v_sub_u32 v146, v146, v134
  v_alignbit_b32 v130, v131, v129, 16
  v_sub_u32 v147, v147, v135
  ds_write_b128 v76, v[124:127] offset:4096
  ds_write_b128 v76, v[128:131] offset:4112
  v_lshl_add_u32 v78, v148, 16, v80
  v_pk_min_u16 v152, v136, 1 op_sel_hi:[1,0]
  v_add_u32 v79, v78, v148
  v_add_u32 v144, v144, v78
  v_perm_b32 v80, v79, v79, s51
  v_lshl_add_u32 v78, v149, 16, v80
  v_pk_min_u16 v153, v137, 1 op_sel_hi:[1,0]
  v_add_u32 v79, v78, v149
  v_add_u32 v145, v145, v78
  v_perm_b32 v80, v79, v79, s51
  v_lshl_add_u32 v78, v150, 16, v80
  v_pk_min_u16 v154, v138, 1 op_sel_hi:[1,0]
  v_add_u32 v79, v78, v150
  v_add_u32 v146, v146, v78
  v_perm_b32 v80, v79, v79, s51
  v_lshl_add_u32 v78, v151, 16, v80
  v_pk_min_u16 v155, v139, 1 op_sel_hi:[1,0]
  v_add_u32 v79, v78, v151
  v_add_u32 v147, v147, v78
  v_perm_b32 v80, v79, v79, s51
  v_add_u32 v140, v144, v136
  v_sub_u32 v116, v144, v124
  v_add_u32 v141, v145, v137
  v_sub_u32 v118, v145, v126
  v_add_u32 v142, v146, v138
  v_sub_u32 v120, v146, v128
  v_add_u32 v143, v147, v139
  v_sub_u32 v122, v147, v130
  v_readlane_b32 s56, v80, 0
  v_readlane_b32 s57, v80, 63
  v_pk_mul_lo_u16 v152, v152, v140
  v_lshrrev_b32 v117, 16, v116
  v_pk_mul_lo_u16 v153, v153, v141
  v_lshrrev_b32 v119, 16, v118
  v_pk_mul_lo_u16 v154, v154, v142
  v_lshrrev_b32 v121, 16, v120
  v_pk_mul_lo_u16 v155, v155, v143
  v_lshrrev_b32 v123, 16, v122
  v_and_b32 v78, 0xffff, v61
  v_cndmask_b32 v78, 0, v78, s[88:89]
  s_movk_i32 s51, 6144
  v_sub_u16_sdwa v116, v78, v124 dst_sel:WORD_1 dst_unused:UNUSED_PRESERVE src0_sel:WORD_0 src1_sel:WORD_0
  v_max_u32_sdwa v78, v78, v152 dst_sel:DWORD dst_unused:UNUSED_PAD src0_sel:DWORD src1_sel:WORD_0
  v_sub_u16_sdwa v117, v78, v125 dst_sel:WORD_1 dst_unused:UNUSED_PRESERVE src0_sel:WORD_0 src1_sel:WORD_0
  v_max_u32_sdwa v78, v78, v152 dst_sel:DWORD dst_unused:UNUSED_PAD src0_sel:DWORD src1_sel:WORD_1
  v_sub_u16_sdwa v118, v78, v126 dst_sel:WORD_1 dst_unused:UNUSED_PRESERVE src0_sel:WORD_0 src1_sel:WORD_0
  v_max_u32_sdwa v78, v78, v153 dst_sel:DWORD dst_unused:UNUSED_PAD src0_sel:DWORD src1_sel:WORD_0
  v_sub_u16_sdwa v119, v78, v127 dst_sel:WORD_1 dst_unused:UNUSED_PRESERVE src0_sel:WORD_0 src1_sel:WORD_0
  v_max_u32_sdwa v78, v78, v153 dst_sel:DWORD dst_unused:UNUSED_PAD src0_sel:DWORD src1_sel:WORD_1
  v_sub_u16_sdwa v120, v78, v128 dst_sel:WORD_1 dst_unused:UNUSED_PRESERVE src0_sel:WORD_0 src1_sel:WORD_0
  v_max_u32_sdwa v78, v78, v154 dst_sel:DWORD dst_unused:UNUSED_PAD src0_sel:DWORD src1_sel:WORD_0
  v_sub_u16_sdwa v121, v78, v129 dst_sel:WORD_1 dst_unused:UNUSED_PRESERVE src0_sel:WORD_0 src1_sel:WORD_0
  v_max_u32_sdwa v78, v78, v154 dst_sel:DWORD dst_unused:UNUSED_PAD src0_sel:DWORD src1_sel:WORD_1
  v_sub_u16_sdwa v122, v78, v130 dst_sel:WORD_1 dst_unused:UNUSED_PRESERVE src0_sel:WORD_0 src1_sel:WORD_0
  v_max_u32_sdwa v78, v78, v155 dst_sel:DWORD dst_unused:UNUSED_PAD src0_sel:DWORD src1_sel:WORD_0
  v_sub_u16_sdwa v123, v78, v131 dst_sel:WORD_1 dst_unused:UNUSED_PRESERVE src0_sel:WORD_0 src1_sel:WORD_0
  v_writelane_b32 v116, s51, 62
  ds_write_b128 v76, v[116:119] offset:2048
  ds_write_b128 v76, v[120:123] offset:2064
  s_pack_hh_b32_b16 s50, s56, s57
  s_sub_u32 s50, s50, 0x6b011b01
  v_mov_b32 v152, s50
  v_mov_b32 v153, s43
  v_mov_b32 v154, s46
  ds_write_b96 v77, v[152:154] offset:2008
  s_setprio 0
  s_waitcnt lgkmcnt(0)
K_scanneda:
  s_cmp_lg_u32 s3, 4
  s_barrier
  ds_read_b96 v[152:154], v77 offset:2008
  ds_read2st64_b32 v[60:61], v44 offset0:8 offset1:16
  ds_read2st64_b32 v[62:63], v45 offset0:8 offset1:16
  ds_read2st64_b32 v[64:65], v46 offset0:8 offset1:16
  ds_read2st64_b32 v[66:67], v47 offset0:8 offset1:16
  ds_read2st64_b32 v[68:69], v48 offset0:8 offset1:16
  ds_read2st64_b32 v[70:71], v49 offset0:8 offset1:16
  ds_read2st64_b32 v[72:73], v50 offset0:8 offset1:16
  ds_read2st64_b32 v[74:75], v51 offset0:8 offset1:16
  s_cbranch_scc1 K_resta
  v_and_b32 v3, 28, v48
  v_cmp_gt_u32 vcc, s60, v3
  s_and_b64 exec, vcc, s[72:73]
  buffer_load_dword v201, v109, s[16:19], 0 offen
  s_mov_b64 exec, -1
  v_and_b32 v3, 28, v49
  v_cmp_gt_u32 vcc, s60, v3
  s_and_b64 exec, vcc, s[74:75]
  buffer_load_dword v201, v111, s[16:19], 0 offen
  s_mov_b64 exec, -1
  v_and_b32 v3, 28, v50
  v_cmp_gt_u32 vcc, s60, v3
  s_and_b64 exec, vcc, s[76:77]
  buffer_load_dword v201, v113, s[16:19], 0 offen
  s_mov_b64 exec, -1
  v_and_b32 v3, 28, v51
  v_cmp_gt_u32 vcc, s60, v3
  s_and_b64 exec, vcc, s[78:79]
  buffer_load_dword v201, v115, s[16:19], 0 offen
  s_mov_b64 exec, -1
K_resta:
  s_waitcnt lgkmcnt(8)
  v_readfirstlane_b32 s50, v152
  v_readfirstlane_b32 s43, v153
  v_readfirstlane_b32 s46, v154
  s_bfe_u32 s56, s50, 0x80008
  s_lshr_b32 s57, s50, 24
  s_max_u32 s57, s57, 1
  s_max_u32 s58, s56, s57
  s_cmp_le_u32 s58, 72
  s_cbranch_scc0 K_over
  s_sub_u32 s59, s58, 1
  s_max_u32 s59, s59, s57
  s_add_u32 s56, s58, 1
  s_and_b32 s56, s56, -2
  s_cmp_lt_u32 s58, 9
  s_cselect_b32 s58, s56, s58
  s_cselect_b32 s59, s56, s59
  s_sub_u32 s61, s58, s59
  s_cmp_eq_u32 s36, 0
  s_cselect_b32 s41, s58, s59
  s_waitcnt lgkmcnt(4)
  v_cmp_lt_u32_sdwa s[80:81], v52, v61 src0_sel:DWORD src1_sel:WORD_0
  v_lshrrev_b32 v61, 16, v60
  v_cmp_lt_u32_sdwa s[82:83], v53, v63 src0_sel:DWORD src1_sel:WORD_0
  v_lshrrev_b32 v63, 16, v62
  v_cmp_lt_u32_sdwa s[84:85], v54, v65 src0_sel:DWORD src1_sel:WORD_0
  v_lshrrev_b32 v65, 16, v64
  v_cmp_lt_u32_sdwa s[86:87], v55, v67 src0_sel:DWORD src1_sel:WORD_0
  v_lshrrev_b32 v67, 16, v66
  v_cndmask_b32 v60, v60, v61, s[80:81]
  v_add_u32_sdwa v52, v52, v60 dst_sel:DWORD dst_unused:UNUSED_PAD src0_sel:DWORD src1_sel:WORD_0
  v_cndmask_b32 v62, v62, v63, s[82:83]
  v_add_u32_sdwa v53, v53, v62 dst_sel:DWORD dst_unused:UNUSED_PAD src0_sel:DWORD src1_sel:WORD_0
  v_cndmask_b32 v64, v64, v65, s[84:85]
  v_add_u32_sdwa v54, v54, v64 dst_sel:DWORD dst_unused:UNUSED_PAD src0_sel:DWORD src1_sel:WORD_0
  v_cndmask_b32 v66, v66, v67, s[86:87]
  v_add_u32_sdwa v55, v55, v66 dst_sel:DWORD dst_unused:UNUSED_PAD src0_sel:DWORD src1_sel:WORD_0
  s_waitcnt lgkmcnt(0)
  v_cmp_lt_u32_sdwa s[80:81], v56, v69 src0_sel:DWORD src1_sel:WORD_0
  v_lshrrev_b32 v69, 16, v68
  v_cmp_lt_u32_sdwa s[82:83], v57, v71 src0_sel:DWORD src1_sel:WORD_0
  v_lshrrev_b32 v71, 16, v70
  v_cmp_lt_u32_sdwa s[84:85], v58, v73 src0_sel:DWORD src1_sel:WORD_0
  v_lshrrev_b32 v73, 16, v72
  v_cmp_lt_u32_sdwa s[86:87], v59, v75 src0_sel:DWORD src1_sel:WORD_0
  v_lshrrev_b32 v75, 16, v74
  v_cndmask_b32 v68, v68, v69, s[80:81]
  v_add_u32_sdwa v56, v56, v68 dst_sel:DWORD dst_unused:UNUSED_PAD src0_sel:DWORD src1_sel:WORD_0
  v_cndmask_b32 v70, v70, v71, s[82:83]
  v_add_u32_sdwa v57, v57, v70 dst_sel:DWORD dst_unused:UNUSED_PAD src0_sel:DWORD src1_sel:WORD_0
  v_cndmask_b32 v72, v72, v73, s[84:85]
  v_add_u32_sdwa v58, v58, v72 dst_sel:DWORD dst_unused:UNUSED_PAD src0_sel:DWORD src1_sel:WORD_0
  v_cndmask_b32 v74, v74, v75, s[86:87]
  v_add_u32_sdwa v59, v59, v74 dst_sel:DWORD dst_unused:UNUSED_PAD src0_sel:DWORD src1_sel:WORD_0
  s_mov_b64 exec, s[64:65]
  ds_write_b64 v52, v[100:101]
  s_mov_b64 exec, s[66:67]
  ds_write_b64 v53, v[102:103]
  s_mov_b64 exec, s[68:69]
  ds_write_b64 v54, v[104:105]
  s_mov_b64 exec, s[70:71]
  ds_write_b64 v55, v[106:107]
  s_mov_b64 exec, s[72:73]
  ds_write_b64 v56, v[108:109]
  s_mov_b64 exec, s[74:75]
  ds_write_b64 v57, v[110:111]
  s_mov_b64 exec, s[76:77]
  ds_write_b64 v58, v[112:113]
  s_mov_b64 exec, s[78:79]
  ds_write_b64 v59, v[114:115]
  s_mov_b64 exec, -1
K_sorted:
  s_cmp_lg_u32 s3, 4
  s_cbranch_scc1 K_c2
  v_and_b32 v90, 5, v89
  v_bfe_u32 v96, v89, 3, 1
  v_lshl_add_u32 v90, v96, 1, v90
  v_lshrrev_b32 v96, 4, v89
  v_lshl_add_u32 v90, v96, 3, v90
  v_mul_u32_u24 v90, 576, v90
  v_lshl_add_u32 v3, v88, 4, v90
  ds_read_b128 v[4:7], v3 offset:48192
  v_lshrrev_b32 v90, 3, v89
  v_and_b32 v96, 1, v89
  v_lshl_add_u32 v90, v90, 1, v96
  v_and_b32 v96, 4, v89
  v_lshl_add_u32 v90, v96, 1, v90
  v_mul_u32_u24 v90, 576, v90
  v_lshl_add_u32 v3, v88, 4, v90
  ds_read_b128 v[12:15], v3 offset:48192
K_c2:
  s_cmp_lg_u32 s3, 7
  s_cbranch_scc1 K_t_done
  s_mov_b32 s50, 0
  s_mov_b32 s51, 10485760
K_t_spin:
  s_waitcnt vmcnt(0)
  v_and_b32 v156, v156, v157
  v_and_b32 v158, v158, v159
  v_and_b32 v156, v156, v158
  v_cmp_ne_u32 vcc, 1, v156
  s_cbranch_vccz K_t_done
  s_add_u32 s50, s50, 1
  s_cmp_lt_u32 s50, 0x40000
  buffer_load_dwordx4 v[156:159], v171, s[12:15], s51 offen sc1
  s_cbranch_scc1 K_t_spin
K_t_done:
  s_waitcnt lgkmcnt(0)
  s_barrier
  s_sub_u32 s24, s4, 3072
  s_subb_u32 s25, s5, 0
  s_mov_b32 s26, s14
  ds_read_b32 v178, v186 offset:20
  ds_read_b32 v1, v186 offset:516
  ds_read2_b32 v[104:105], v185 offset0:4 offset1:20
  ds_read2_b32 v[106:107], v185 offset0:36 offset1:52
  ds_read2_b32 v[188:189], v187 offset0:6 offset1:38
  s_waitcnt lgkmcnt(0)
  s_add_u32 m0, s40, 1024
  s_mov_b64 exec, 0xffff
  v_or_b32 v178, v178, v179
  buffer_load_dwordx4 v178, s[16:19], 0 offen  lds
  s_mov_b64 exec, -1
  s_add_u32 m0, s40, 2048
  s_mov_b64 exec, 0xffff
  v_or_b32 v1, v1, v179
  buffer_load_dwordx4 v1, s[16:19], 0 offen  lds
  s_mov_b64 exec, -1
  s_add_u32 m0, s39, 4096
  v_mad_u32_u16 v172, v104, s47, v207
  buffer_load_dwordx4 v172, s[24:27], 0 offen offset:0 sc1 lds
  v_mad_u32_u16 v173, v105, s47, v182
  buffer_load_dwordx4 v173, s[24:27], 0 offen offset:1024 sc1 lds
  v_mad_u32_u16 v174, v106, s47, v177
  buffer_load_dwordx4 v174, s[24:27], 0 offen offset:2048 sc1 lds
  v_mad_u32_u16 v175, v107, s47, v176
  buffer_load_dwordx4 v175, s[24:27], 0 offen offset:3072 sc1 lds
  ds_read_b32 v178, v186 offset:532
  ds_read2_b32 v[104:105], v185 offset0:128 offset1:144
  ds_read2_b32 v[106:107], v185 offset0:160 offset1:176
  v_add_u32_sdwa v188, v188, v190 dst_sel:DWORD dst_unused:UNUSED_PAD src0_sel:WORD_1 src1_sel:DWORD
  v_add_u32_sdwa v189, v189, v190 dst_sel:DWORD dst_unused:UNUSED_PAD src0_sel:WORD_1 src1_sel:DWORD
  s_mov_b32 s51, 0xffff0000
  v_lshlrev_b32 v76, 16, v164
  v_and_b32 v77, s51, v164
  v_pk_mul_f32 v[76:77], v[76:77], s[94:95]
  v_cvt_pk_bf16_f32 v16, v76, v77
  v_lshlrev_b32 v76, 16, v165
  v_and_b32 v77, s51, v165
  v_pk_mul_f32 v[76:77], v[76:77], s[94:95]
  v_cvt_pk_bf16_f32 v17, v76, v77
  v_lshlrev_b32 v76, 16, v166
  v_and_b32 v77, s51, v166
  v_pk_mul_f32 v[76:77], v[76:77], s[94:95]
  v_cvt_pk_bf16_f32 v18, v76, v77
  v_lshlrev_b32 v76, 16, v167
  v_and_b32 v77, s51, v167
  v_pk_mul_f32 v[76:77], v[76:77], s[94:95]
  v_cvt_pk_bf16_f32 v19, v76, v77
  v_lshl_add_u32 v90, v88, 9, s39
  v_lshl_add_u32 v181, v89, 1, v90
  v_add_u32 v90, v90, v91
  v_and_b32 v91, 12, v2
  v_lshl_add_u32 v90, v91, 5, v90
  v_and_b32 v91, 8, v2
  v_lshl_add_u32 v180, v91, 3, v90
  v_and_b32 v90, 2, v2
  v_mul_u32_u24 v90, 0x5555, v90
  v_add_u32 v8, 0x4444, v90
  v_xor_b32 v84, v97, v88
  v_lshlrev_b32 v84, 4, v84
  v_and_b32 v90, 0x13, v2
  v_lshl_add_u32 v84, v90, 5, v84
  v_and_b32 v90, 4, v2
  v_lshl_add_u32 v84, v90, 6, v84
  v_and_b32 v90, 8, v2
  v_lshl_add_u32 v84, v90, 4, v84
  v_add_u32 v184, s93, v84
  v_mov_b32 v108, 0
  v_mov_b32 v109, 0
  v_mov_b32 v110, 0
  v_mov_b32 v111, 0
  s_sub_u32 s51, 3200000, s8
  s_min_u32 s34, s51, 12544
  s_add_u32 s32, s10, s8
  s_addc_u32 s33, s11, 0
  v_mfma_f32_32x32x16_bf16 v[208:223], v[108:111], v[108:111], 0
  s_mov_b32 s48, 0x27800000
  s_mov_b32 s49, 0x27800000
  v_mfma_f32_32x32x16_bf16 v[224:239], v[108:111], v[108:111], 0
K_fillb:
  s_and_b32 s50, s41, 1
  s_cmp_gt_u32 s50, s37
  s_cbranch_scc0 K_nospread
  s_mul_i32 s50, s36, 20480
  s_lshl_b32 s51, s41, 8
  s_add_u32 s50, s50, s51
  v_lshrrev_b32 v108, 1, v2
  v_bfi_b32 v108, 1, v2, v108
  v_lshl_add_u32 v108, v108, 3, s50
  v_and_b32 v109, 2, v2
  v_lshl_add_u32 v108, v109, 7, v108
  ds_read_b64 v[110:111], v108 offset:6912
  v_lshl_add_u32 v108, v2, 3, s50
  s_waitcnt lgkmcnt(0)
  ds_write_b64 v108, v[110:111] offset:6912
K_nospread:
  ds_read_b64_tr_b16 v[120:121], v188
  ds_read_b64_tr_b16 v[122:123], v189
  ds_read_b64_tr_b16 v[124:125], v188 offset:64
  ds_read_b64_tr_b16 v[126:127], v189 offset:64
  s_waitcnt lgkmcnt(0)
  s_add_u32 m0, s40, 3072
  s_mov_b64 exec, 0xffff
  v_or_b32 v178, v178, v179
  buffer_load_dwordx4 v178, s[16:19], 0 offen  lds
  s_mov_b64 exec, -1
  s_add_u32 m0, s39, 0
  v_mad_u32_u16 v172, v104, s47, v207
  buffer_load_dwordx4 v172, s[24:27], 0 offen offset:0 sc1 lds
  v_mad_u32_u16 v173, v105, s47, v182
  buffer_load_dwordx4 v173, s[24:27], 0 offen offset:1024 sc1 lds
  v_mad_u32_u16 v174, v106, s47, v177
  buffer_load_dwordx4 v174, s[24:27], 0 offen offset:2048 sc1 lds
  v_mad_u32_u16 v175, v107, s47, v176
  buffer_load_dwordx4 v175, s[24:27], 0 offen offset:3072 sc1 lds
  ds_read_b32 v178, v186 offset:1028
  ds_read2_b32 v[104:105], v185 offset0:132 offset1:148
  ds_read2_b32 v[106:107], v185 offset0:164 offset1:180
  ds_read2_b32 v[188:189], v187 offset0:128 offset1:160
  v_add_u32 v187, 0x200, v187
  v_add_u32 v185, 0x400, v185
  s_sub_u32 s42, s41, 2
  v_mfma_f32_32x32x16_bf16 v[84:99], v[12:15], v[120:123], 0
  s_waitcnt lgkmcnt(0)
  v_mad_u32_u16 v172, v104, s47, v207
  v_mad_u32_u16 v173, v105, s47, v182
  v_mad_u32_u16 v174, v106, s47, v177
  v_mad_u32_u16 v175, v107, s47, v176
  v_add_u32_sdwa v188, v188, v190 dst_sel:DWORD dst_unused:UNUSED_PAD src0_sel:WORD_1 src1_sel:DWORD
  v_add_u32_sdwa v189, v189, v190 dst_sel:DWORD dst_unused:UNUSED_PAD src0_sel:WORD_1 src1_sel:DWORD
  v_mov_b32 v132, 0
  v_mov_b32 v133, 0
  v_mov_b32 v134, 0
  v_mov_b32 v135, 0
  v_mov_b32 v136, 0
  v_mov_b32 v137, 0
  v_mov_b32 v138, 0
  v_mov_b32 v139, 0
  v_mov_b32 v140, 0
  v_mov_b32 v141, 0
  v_mov_b32 v142, 0
  v_mov_b32 v143, 0
  v_mov_b32 v144, 0
  v_mov_b32 v145, 0
  v_mov_b32 v146, 0
  v_mov_b32 v147, 0
  v_mov_b32 v248, 0
  v_mov_b32 v249, 0
  v_mov_b32 v250, 0
  v_mov_b32 v251, 0
  v_mov_b32 v252, 0
  v_mov_b32 v253, 0
  v_mov_b32 v254, 0
  v_mov_b32 v255, 0
  s_cmp_eq_u32 s36, 0
  s_cbranch_scc1 K_lead
  s_barrier
K_lead:
  s_waitcnt vmcnt(5)
  s_barrier
  ds_read_b128 v[100:103], v184 offset:1024
  ds_read_b64_tr_b16 v[108:109], v180 offset:4096
  ds_read_b64_tr_b16 v[110:111], v180 offset:5120
  ds_read_b64_tr_b16 v[112:113], v180 offset:6144
  ds_read_b64_tr_b16 v[114:115], v180 offset:7168
  ds_read_u16_d16_hi v36, v181 offset:4160
  ds_read_u16_d16_hi v37, v181 offset:4288
  ds_read_u16_d16_hi v38, v181 offset:4352
  ds_read_u16_d16_hi v39, v181 offset:4480
  ds_read_u16_d16_hi v40, v181 offset:5184
  ds_read_u16_d16_hi v41, v181 offset:5312
  s_add_u32 m0, s40, 0
  s_mov_b64 exec, 0xffff
  v_or_b32 v178, v178, v179
  buffer_load_dwordx4 v178, s[16:19], 0 offen  lds
  s_mov_b64 exec, -1
  ds_read_u16_d16_hi v42, v181 offset:5376
  ds_read_u16_d16_hi v43, v181 offset:5504
  ds_read_u16_d16_hi v44, v181 offset:6208
  ds_read_u16_d16_hi v45, v181 offset:6336
  ds_read_u16_d16_hi v46, v181 offset:6400
  ds_read_u16_d16_hi v47, v181 offset:6528
  ds_read_u16_d16_hi v48, v181 offset:7232
  ds_read_u16_d16_hi v49, v181 offset:7360
  ds_read_u16_d16_hi v50, v181 offset:7424
  s_waitcnt lgkmcnt(15)
  v_mfma_f32_32x32x16_bf16 v[68:83], v[100:103], v[16:19], v[84:99]
  v_smfmac_f32_32x32x32_bf16 v[68:83], v[4:7], v[108:115], v8
  ds_read_u16_d16_hi v51, v181 offset:7552
  ds_read_b32 v178, v186 offset:1044
  s_waitcnt lgkmcnt(0)
  v_or_b32 v178, v178, v179
  s_setprio 1
  s_barrier
.p2align 6
K_loop:
  s_add_u32 m0, s39, 4096
  ds_read_b32 v183, v186 offset:1540
  buffer_load_dwordx4 v172, s[24:27], 0 offen offset:0 sc1 lds
  ds_read2_b32 v[104:105], v185 offset0:0 offset1:16
  ds_read2_b32 v[106:107], v185 offset0:32 offset1:48
  buffer_load_dwordx4 v173, s[24:27], 0 offen offset:1024 sc1 lds
  ds_read_b64_tr_b16 v[120:121], v188
  ds_read_b64_tr_b16 v[122:123], v189
  buffer_load_dwordx4 v174, s[24:27], 0 offen offset:2048 sc1 lds
  ds_read_b64_tr_b16 v[128:129], v188 offset:64
  ds_read_b64_tr_b16 v[130:131], v189 offset:64
  buffer_load_dwordx4 v175, s[24:27], 0 offen offset:3072 sc1 lds
  s_add_u32 m0, s40, 1024
  s_mov_b64 exec, 0xffff
  buffer_load_dwordx4 v178, s[16:19], 0 offen  lds
  s_mov_b64 exec, -1
  s_waitcnt vmcnt(6)
  ds_read_b128 v[100:103], v184 offset:2048
  ds_read_b64_tr_b16 v[108:109], v180 offset:0
  ds_read_b64_tr_b16 v[110:111], v180 offset:1024
  ds_read_b64_tr_b16 v[112:113], v180 offset:2048
  ds_read_b64_tr_b16 v[114:115], v180 offset:3072
  ds_read_u16_d16_hi v20, v181 offset:64
  ds_read_u16_d16_hi v21, v181 offset:192
  ds_read_u16_d16_hi v22, v181 offset:256
  ds_read_u16_d16_hi v23, v181 offset:384
  ds_read_u16_d16_hi v24, v181 offset:1088
  ds_read_u16_d16_hi v25, v181 offset:1216
  ds_read_u16_d16_hi v26, v181 offset:1280
  ds_read_u16_d16_hi v27, v181 offset:1408
  ds_read_u16_d16_hi v28, v181 offset:2112
  ds_read_u16_d16_hi v29, v181 offset:2240
  ds_read_u16_d16_hi v30, v181 offset:2304
  ds_read_u16_d16_hi v31, v181 offset:2432
  ds_read_u16_d16_hi v32, v181 offset:3136
  ds_read_u16_d16_hi v33, v181 offset:3264
  ds_read_u16_d16_hi v34, v181 offset:3328
  ds_read_u16_d16_hi v35, v181 offset:3456
  s_waitcnt lgkmcnt(15)
  v_mad_u32_u16 v172, v104, s47, v207
  v_mad_u32_u16 v173, v105, s47, v182
  v_mad_u32_u16 v174, v106, s47, v177
  v_mad_u32_u16 v175, v107, s47, v176
  v_or_b32 v178, v183, v179
  s_sub_u32 s42, s42, 1
  s_setprio 0
  s_waitcnt lgkmcnt(0)
  s_barrier
  v_pk_mul_f32 v[148:149], v[132:133], v[248:249]
  v_pk_mul_f32 v[150:151], v[134:135], v[250:251]
  v_pk_mul_f32 v[152:153], v[136:137], v[252:253]
  v_pk_mul_f32 v[154:155], v[138:139], v[254:255]
  v_pk_mul_f32 v[156:157], v[140:141], v[248:249]
  v_pk_mul_f32 v[158:159], v[142:143], v[250:251]
  v_pk_mul_f32 v[160:161], v[144:145], v[252:253]
  v_pk_mul_f32 v[162:163], v[146:147], v[254:255]
  v_mfma_f32_32x32x16_bf16 v[84:99], v[12:15], v[120:123], 0
  v_exp_f32 v68, v68
  v_exp_f32 v69, v69
  v_exp_f32 v70, v70
  v_mfma_f32_32x32x16_bf16 v[52:67], v[100:103], v[16:19], v[84:99]
  v_exp_f32 v71, v71
  v_exp_f32 v72, v72
  v_exp_f32 v73, v73
  v_smfmac_f32_32x32x32_bf16 v[52:67], v[4:7], v[108:115], v8
  v_exp_f32 v74, v74
  v_exp_f32 v75, v75
  v_exp_f32 v76, v76
  v_exp_f32 v77, v77
  v_exp_f32 v78, v78
  v_exp_f32 v79, v79
  v_exp_f32 v80, v80
  v_exp_f32 v81, v81
  v_exp_f32 v82, v82
  v_exp_f32 v83, v83
  v_pk_fma_f32 v[68:69], v[68:69], s[48:49], s[48:49] clamp
  v_pk_fma_f32 v[70:71], v[70:71], s[48:49], s[48:49] clamp
  v_pk_fma_f32 v[72:73], v[72:73], s[48:49], s[48:49] clamp
  v_pk_fma_f32 v[74:75], v[74:75], s[48:49], s[48:49] clamp
  v_pk_fma_f32 v[76:77], v[76:77], s[48:49], s[48:49] clamp
  v_pk_fma_f32 v[78:79], v[78:79], s[48:49], s[48:49] clamp
  v_pk_fma_f32 v[80:81], v[80:81], s[48:49], s[48:49] clamp
  v_pk_fma_f32 v[82:83], v[82:83], s[48:49], s[48:49] clamp
  v_pk_mul_f32 v[248:249], v[68:69], v[70:71]
  v_pk_mul_f32 v[140:141], v[36:37], v[70:71]
  v_rcp_f32 v248, v248
  v_pk_add_f32 v[132:133], v[68:69], v[70:71]
  v_rcp_f32 v249, v249
  v_pk_fma_f32 v[140:141], v[38:39], v[68:69], v[140:141]
  v_pk_mul_f32 v[250:251], v[72:73], v[74:75]
  v_pk_mul_f32 v[142:143], v[40:41], v[74:75]
  v_rcp_f32 v250, v250
  v_pk_add_f32 v[134:135], v[72:73], v[74:75]
  v_rcp_f32 v251, v251
  v_pk_fma_f32 v[142:143], v[42:43], v[72:73], v[142:143]
  v_pk_mul_f32 v[252:253], v[76:77], v[78:79]
  v_pk_mul_f32 v[144:145], v[44:45], v[78:79]
  v_rcp_f32 v252, v252
  v_pk_add_f32 v[136:137], v[76:77], v[78:79]
  v_rcp_f32 v253, v253
  v_pk_fma_f32 v[144:145], v[46:47], v[76:77], v[144:145]
  v_pk_mul_f32 v[254:255], v[80:81], v[82:83]
  v_pk_mul_f32 v[146:147], v[48:49], v[82:83]
  v_rcp_f32 v254, v254
  v_pk_add_f32 v[138:139], v[80:81], v[82:83]
  v_rcp_f32 v255, v255
  v_pk_fma_f32 v[146:147], v[50:51], v[80:81], v[146:147]
  s_setprio 1
  s_barrier
  s_cbranch_scc1 K_drain0
  s_add_u32 m0, s39, 0
  ds_read_b32 v183, v186 offset:1556
  buffer_load_dwordx4 v172, s[24:27], 0 offen offset:0 sc1 lds
  ds_read2_b32 v[104:105], v185 offset0:4 offset1:20
  buffer_load_dwordx4 v173, s[24:27], 0 offen offset:1024 sc1 lds
  ds_read2_b32 v[106:107], v185 offset0:36 offset1:52
  buffer_load_dwordx4 v174, s[24:27], 0 offen offset:2048 sc1 lds
  ds_read2_b32 v[188:189], v187 offset0:128 offset1:160
  buffer_load_dwordx4 v175, s[24:27], 0 offen offset:3072 sc1 lds
  s_add_u32 m0, s40, 2048
  s_mov_b64 exec, 0xffff
  buffer_load_dwordx4 v178, s[16:19], 0 offen  lds
  s_mov_b64 exec, -1
  s_waitcnt vmcnt(6)
  ds_read_b128 v[100:103], v184 offset:3072
  ds_read_b64_tr_b16 v[108:109], v180 offset:4096
  ds_read_b64_tr_b16 v[110:111], v180 offset:5120
  ds_read_b64_tr_b16 v[112:113], v180 offset:6144
  ds_read_b64_tr_b16 v[114:115], v180 offset:7168
  ds_read_u16_d16_hi v36, v181 offset:4160
  ds_read_u16_d16_hi v37, v181 offset:4288
  ds_read_u16_d16_hi v38, v181 offset:4352
  ds_read_u16_d16_hi v39, v181 offset:4480
  ds_read_u16_d16_hi v40, v181 offset:5184
  ds_read_u16_d16_hi v41, v181 offset:5312
  ds_read_u16_d16_hi v42, v181 offset:5376
  ds_read_u16_d16_hi v43, v181 offset:5504
  ds_read_u16_d16_hi v44, v181 offset:6208
  ds_read_u16_d16_hi v45, v181 offset:6336
  ds_read_u16_d16_hi v46, v181 offset:6400
  ds_read_u16_d16_hi v47, v181 offset:6528
  ds_read_u16_d16_hi v48, v181 offset:7232
  ds_read_u16_d16_hi v49, v181 offset:7360
  ds_read_u16_d16_hi v50, v181 offset:7424
  ds_read_u16_d16_hi v51, v181 offset:7552
  s_waitcnt lgkmcnt(15)
  v_mad_u32_u16 v172, v104, s47, v207
  v_mad_u32_u16 v173, v105, s47, v182
  v_mad_u32_u16 v174, v106, s47, v177
  v_mad_u32_u16 v175, v107, s47, v176
  v_or_b32 v178, v183, v179
  v_add_u32_sdwa v188, v188, v190 dst_sel:DWORD dst_unused:UNUSED_PAD src0_sel:WORD_1 src1_sel:DWORD
  v_add_u32_sdwa v189, v189, v190 dst_sel:DWORD dst_unused:UNUSED_PAD src0_sel:WORD_1 src1_sel:DWORD
  v_add_u32 v187, 0x400, v187
  s_sub_u32 s42, s42, 1
  s_setprio 0
  s_waitcnt lgkmcnt(0)
  s_barrier
  v_pk_fma_f32 v[148:149], v[132:133], v[248:249], v[148:149]
  v_pk_fma_f32 v[150:151], v[134:135], v[250:251], v[150:151]
  v_pk_fma_f32 v[152:153], v[136:137], v[252:253], v[152:153]
  v_pk_fma_f32 v[154:155], v[138:139], v[254:255], v[154:155]
  v_pk_fma_f32 v[156:157], v[140:141], v[248:249], v[156:157]
  v_pk_fma_f32 v[158:159], v[142:143], v[250:251], v[158:159]
  v_pk_fma_f32 v[160:161], v[144:145], v[252:253], v[160:161]
  v_pk_fma_f32 v[162:163], v[146:147], v[254:255], v[162:163]
  v_mfma_f32_32x32x16_bf16 v[68:83], v[100:103], v[16:19], v[84:99]
  v_cvt_pk_bf16_f32 v164, v148, v149
  v_cvt_pk_bf16_f32 v165, v150, v151
  v_cvt_pk_bf16_f32 v166, v152, v153
  v_cvt_pk_bf16_f32 v167, v154, v155
  v_cvt_pk_bf16_f32 v168, v156, v157
  v_cvt_pk_bf16_f32 v169, v158, v159
  v_smfmac_f32_32x32x32_bf16 v[68:83], v[4:7], v[108:115], v8
  v_cvt_pk_bf16_f32 v170, v160, v161
  v_cvt_pk_bf16_f32 v171, v162, v163
  v_exp_f32 v52, v52
  v_exp_f32 v53, v53
  v_mfma_f32_32x32x16_bf16 v[208:223], v[124:127], v[164:167], v[208:223]
  v_exp_f32 v54, v54
  v_exp_f32 v55, v55
  v_exp_f32 v56, v56
  v_mfma_f32_32x32x16_bf16 v[224:239], v[124:127], v[168:171], v[224:239]
  v_exp_f32 v57, v57
  v_exp_f32 v58, v58
  v_exp_f32 v59, v59
  v_exp_f32 v60, v60
  v_exp_f32 v61, v61
  v_exp_f32 v62, v62
  v_exp_f32 v63, v63
  v_exp_f32 v64, v64
  v_exp_f32 v65, v65
  v_exp_f32 v66, v66
  v_exp_f32 v67, v67
  v_pk_fma_f32 v[52:53], v[52:53], s[48:49], s[48:49] clamp
  v_pk_fma_f32 v[54:55], v[54:55], s[48:49], s[48:49] clamp
  v_pk_fma_f32 v[56:57], v[56:57], s[48:49], s[48:49] clamp
  v_pk_fma_f32 v[58:59], v[58:59], s[48:49], s[48:49] clamp
  v_pk_fma_f32 v[60:61], v[60:61], s[48:49], s[48:49] clamp
  v_pk_fma_f32 v[62:63], v[62:63], s[48:49], s[48:49] clamp
  v_pk_fma_f32 v[64:65], v[64:65], s[48:49], s[48:49] clamp
  v_pk_fma_f32 v[66:67], v[66:67], s[48:49], s[48:49] clamp
  v_pk_mul_f32 v[248:249], v[52:53], v[54:55]
  v_pk_mul_f32 v[140:141], v[20:21], v[54:55]
  v_rcp_f32 v248, v248
  v_pk_add_f32 v[132:133], v[52:53], v[54:55]
  v_rcp_f32 v249, v249
  v_pk_fma_f32 v[140:141], v[22:23], v[52:53], v[140:141]
  v_pk_mul_f32 v[250:251], v[56:57], v[58:59]
  v_pk_mul_f32 v[142:143], v[24:25], v[58:59]
  v_rcp_f32 v250, v250
  v_pk_add_f32 v[134:135], v[56:57], v[58:59]
  v_rcp_f32 v251, v251
  v_pk_fma_f32 v[142:143], v[26:27], v[56:57], v[142:143]
  v_pk_mul_f32 v[252:253], v[60:61], v[62:63]
  v_pk_mul_f32 v[144:145], v[28:29], v[62:63]
  v_rcp_f32 v252, v252
  v_pk_add_f32 v[136:137], v[60:61], v[62:63]
  v_rcp_f32 v253, v253
  v_pk_fma_f32 v[144:145], v[30:31], v[60:61], v[144:145]
  v_pk_mul_f32 v[254:255], v[64:65], v[66:67]
  v_pk_mul_f32 v[146:147], v[32:33], v[66:67]
  v_rcp_f32 v254, v254
  v_pk_add_f32 v[138:139], v[64:65], v[66:67]
  v_rcp_f32 v255, v255
  v_pk_fma_f32 v[146:147], v[34:35], v[64:65], v[146:147]
  s_setprio 1
  s_barrier
  s_cbranch_scc1 K_drain
  s_add_u32 m0, s39, 4096
  ds_read_b32 v183, v186 offset:2052
  buffer_load_dwordx4 v172, s[24:27], 0 offen offset:0 sc1 lds
  ds_read2_b32 v[104:105], v185 offset0:128 offset1:144
  ds_read2_b32 v[106:107], v185 offset0:160 offset1:176
  buffer_load_dwordx4 v173, s[24:27], 0 offen offset:1024 sc1 lds
  ds_read_b64_tr_b16 v[120:121], v188
  ds_read_b64_tr_b16 v[122:123], v189
  buffer_load_dwordx4 v174, s[24:27], 0 offen offset:2048 sc1 lds
  ds_read_b64_tr_b16 v[124:125], v188 offset:64
  ds_read_b64_tr_b16 v[126:127], v189 offset:64
  buffer_load_dwordx4 v175, s[24:27], 0 offen offset:3072 sc1 lds
  s_add_u32 m0, s40, 3072
  s_mov_b64 exec, 0xffff
  buffer_load_dwordx4 v178, s[16:19], 0 offen  lds
  s_mov_b64 exec, -1
  s_waitcnt vmcnt(6)
  ds_read_b128 v[100:103], v184 offset:0
  ds_read_b64_tr_b16 v[108:109], v180 offset:0
  ds_read_b64_tr_b16 v[110:111], v180 offset:1024
  ds_read_b64_tr_b16 v[112:113], v180 offset:2048
  ds_read_b64_tr_b16 v[114:115], v180 offset:3072
  ds_read_u16_d16_hi v20, v181 offset:64
  ds_read_u16_d16_hi v21, v181 offset:192
  ds_read_u16_d16_hi v22, v181 offset:256
  ds_read_u16_d16_hi v23, v181 offset:384
  ds_read_u16_d16_hi v24, v181 offset:1088
  ds_read_u16_d16_hi v25, v181 offset:1216
  ds_read_u16_d16_hi v26, v181 offset:1280
  ds_read_u16_d16_hi v27, v181 offset:1408
  ds_read_u16_d16_hi v28, v181 offset:2112
  ds_read_u16_d16_hi v29, v181 offset:2240
  ds_read_u16_d16_hi v30, v181 offset:2304
  ds_read_u16_d16_hi v31, v181 offset:2432
  ds_read_u16_d16_hi v32, v181 offset:3136
  ds_read_u16_d16_hi v33, v181 offset:3264
  ds_read_u16_d16_hi v34, v181 offset:3328
  ds_read_u16_d16_hi v35, v181 offset:3456
  s_waitcnt lgkmcnt(15)
  v_mad_u32_u16 v172, v104, s47, v207
  v_mad_u32_u16 v173, v105, s47, v182
  v_mad_u32_u16 v174, v106, s47, v177
  v_mad_u32_u16 v175, v107, s47, v176
  v_or_b32 v178, v183, v179
  v_add_u32 v186, 0x400, v186
  s_sub_u32 s42, s42, 1
  s_setprio 0
  s_waitcnt lgkmcnt(0)
  s_barrier
  v_pk_mul_f32 v[148:149], v[132:133], v[248:249]
  v_pk_mul_f32 v[150:151], v[134:135], v[250:251]
  v_pk_mul_f32 v[152:153], v[136:137], v[252:253]
  v_pk_mul_f32 v[154:155], v[138:139], v[254:255]
  v_pk_mul_f32 v[156:157], v[140:141], v[248:249]
  v_pk_mul_f32 v[158:159], v[142:143], v[250:251]
  v_pk_mul_f32 v[160:161], v[144:145], v[252:253]
  v_pk_mul_f32 v[162:163], v[146:147], v[254:255]
  v_mfma_f32_32x32x16_bf16 v[84:99], v[12:15], v[120:123], 0
  v_exp_f32 v68, v68
  v_exp_f32 v69, v69
  v_exp_f32 v70, v70
  v_mfma_f32_32x32x16_bf16 v[52:67], v[100:103], v[16:19], v[84:99]
  v_exp_f32 v71, v71
  v_exp_f32 v72, v72
  v_exp_f32 v73, v73
  v_smfmac_f32_32x32x32_bf16 v[52:67], v[4:7], v[108:115], v8
  v_exp_f32 v74, v74
  v_exp_f32 v75, v75
  v_exp_f32 v76, v76
  v_exp_f32 v77, v77
  v_exp_f32 v78, v78
  v_exp_f32 v79, v79
  v_exp_f32 v80, v80
  v_exp_f32 v81, v81
  v_exp_f32 v82, v82
  v_exp_f32 v83, v83
  v_pk_fma_f32 v[68:69], v[68:69], s[48:49], s[48:49] clamp
  v_pk_fma_f32 v[70:71], v[70:71], s[48:49], s[48:49] clamp
  v_pk_fma_f32 v[72:73], v[72:73], s[48:49], s[48:49] clamp
  v_pk_fma_f32 v[74:75], v[74:75], s[48:49], s[48:49] clamp
  v_pk_fma_f32 v[76:77], v[76:77], s[48:49], s[48:49] clamp
  v_pk_fma_f32 v[78:79], v[78:79], s[48:49], s[48:49] clamp
  v_pk_fma_f32 v[80:81], v[80:81], s[48:49], s[48:49] clamp
  v_pk_fma_f32 v[82:83], v[82:83], s[48:49], s[48:49] clamp
  v_pk_mul_f32 v[248:249], v[68:69], v[70:71]
  v_pk_mul_f32 v[140:141], v[36:37], v[70:71]
  v_rcp_f32 v248, v248
  v_pk_add_f32 v[132:133], v[68:69], v[70:71]
  v_rcp_f32 v249, v249
  v_pk_fma_f32 v[140:141], v[38:39], v[68:69], v[140:141]
  v_pk_mul_f32 v[250:251], v[72:73], v[74:75]
  v_pk_mul_f32 v[142:143], v[40:41], v[74:75]
  v_rcp_f32 v250, v250
  v_pk_add_f32 v[134:135], v[72:73], v[74:75]
  v_rcp_f32 v251, v251
  v_pk_fma_f32 v[142:143], v[42:43], v[72:73], v[142:143]
  v_pk_mul_f32 v[252:253], v[76:77], v[78:79]
  v_pk_mul_f32 v[144:145], v[44:45], v[78:79]
  v_rcp_f32 v252, v252
  v_pk_add_f32 v[136:137], v[76:77], v[78:79]
  v_rcp_f32 v253, v253
  v_pk_fma_f32 v[144:145], v[46:47], v[76:77], v[144:145]
  v_pk_mul_f32 v[254:255], v[80:81], v[82:83]
  v_pk_mul_f32 v[146:147], v[48:49], v[82:83]
  v_rcp_f32 v254, v254
  v_pk_add_f32 v[138:139], v[80:81], v[82:83]
  v_rcp_f32 v255, v255
  v_pk_fma_f32 v[146:147], v[50:51], v[80:81], v[146:147]
  s_setprio 1
  s_barrier
  s_cbranch_scc1 K_drain
  s_add_u32 m0, s39, 0
  ds_read_b32 v183, v186 offset:1044
  buffer_load_dwordx4 v172, s[24:27], 0 offen offset:0 sc1 lds
  ds_read2_b32 v[104:105], v185 offset0:132 offset1:148
  buffer_load_dwordx4 v173, s[24:27], 0 offen offset:1024 sc1 lds
  ds_read2_b32 v[106:107], v185 offset0:164 offset1:180
  buffer_load_dwordx4 v174, s[24:27], 0 offen offset:2048 sc1 lds
  ds_read2_b32 v[188:189], v187 offset0:0 offset1:32
  buffer_load_dwordx4 v175, s[24:27], 0 offen offset:3072 sc1 lds
  s_add_u32 m0, s40, 0
  s_mov_b64 exec, 0xffff
  buffer_load_dwordx4 v178, s[16:19], 0 offen  lds
  s_mov_b64 exec, -1
  s_waitcnt vmcnt(6)
  ds_read_b128 v[100:103], v184 offset:1024
  ds_read_b64_tr_b16 v[108:109], v180 offset:4096
  ds_read_b64_tr_b16 v[110:111], v180 offset:5120
  ds_read_b64_tr_b16 v[112:113], v180 offset:6144
  ds_read_b64_tr_b16 v[114:115], v180 offset:7168
  ds_read_u16_d16_hi v36, v181 offset:4160
  ds_read_u16_d16_hi v37, v181 offset:4288
  ds_read_u16_d16_hi v38, v181 offset:4352
  ds_read_u16_d16_hi v39, v181 offset:4480
  ds_read_u16_d16_hi v40, v181 offset:5184
  ds_read_u16_d16_hi v41, v181 offset:5312
  ds_read_u16_d16_hi v42, v181 offset:5376
  ds_read_u16_d16_hi v43, v181 offset:5504
  ds_read_u16_d16_hi v44, v181 offset:6208
  ds_read_u16_d16_hi v45, v181 offset:6336
  ds_read_u16_d16_hi v46, v181 offset:6400
  ds_read_u16_d16_hi v47, v181 offset:6528
  ds_read_u16_d16_hi v48, v181 offset:7232
  ds_read_u16_d16_hi v49, v181 offset:7360
  ds_read_u16_d16_hi v50, v181 offset:7424
  ds_read_u16_d16_hi v51, v181 offset:7552
  s_waitcnt lgkmcnt(15)
  v_mad_u32_u16 v172, v104, s47, v207
  v_mad_u32_u16 v173, v105, s47, v182
  v_mad_u32_u16 v174, v106, s47, v177
  v_mad_u32_u16 v175, v107, s47, v176
  v_or_b32 v178, v183, v179
  v_add_u32_sdwa v188, v188, v190 dst_sel:DWORD dst_unused:UNUSED_PAD src0_sel:WORD_1 src1_sel:DWORD
  v_add_u32_sdwa v189, v189, v190 dst_sel:DWORD dst_unused:UNUSED_PAD src0_sel:WORD_1 src1_sel:DWORD
  v_add_u32 v185, 0x400, v185
  s_sub_u32 s42, s42, 1
  s_setprio 0
  s_waitcnt lgkmcnt(0)
  s_barrier
  v_pk_fma_f32 v[148:149], v[132:133], v[248:249], v[148:149]
  v_pk_fma_f32 v[150:151], v[134:135], v[250:251], v[150:151]
  v_pk_fma_f32 v[152:153], v[136:137], v[252:253], v[152:153]
  v_pk_fma_f32 v[154:155], v[138:139], v[254:255], v[154:155]
  v_pk_fma_f32 v[156:157], v[140:141], v[248:249], v[156:157]
  v_pk_fma_f32 v[158:159], v[142:143], v[250:251], v[158:159]
  v_pk_fma_f32 v[160:161], v[144:145], v[252:253], v[160:161]
  v_pk_fma_f32 v[162:163], v[146:147], v[254:255], v[162:163]
  v_mfma_f32_32x32x16_bf16 v[68:83], v[100:103], v[16:19], v[84:99]
  v_cvt_pk_bf16_f32 v164, v148, v149
  v_cvt_pk_bf16_f32 v165, v150, v151
  v_cvt_pk_bf16_f32 v166, v152, v153
  v_cvt_pk_bf16_f32 v167, v154, v155
  v_cvt_pk_bf16_f32 v168, v156, v157
  v_cvt_pk_bf16_f32 v169, v158, v159
  v_smfmac_f32_32x32x32_bf16 v[68:83], v[4:7], v[108:115], v8
  v_cvt_pk_bf16_f32 v170, v160, v161
  v_cvt_pk_bf16_f32 v171, v162, v163
  v_exp_f32 v52, v52
  v_exp_f32 v53, v53
  v_mfma_f32_32x32x16_bf16 v[208:223], v[128:131], v[164:167], v[208:223]
  v_exp_f32 v54, v54
  v_exp_f32 v55, v55
  v_exp_f32 v56, v56
  v_mfma_f32_32x32x16_bf16 v[224:239], v[128:131], v[168:171], v[224:239]
  v_exp_f32 v57, v57
  v_exp_f32 v58, v58
  v_exp_f32 v59, v59
  v_exp_f32 v60, v60
  v_exp_f32 v61, v61
  v_exp_f32 v62, v62
  v_exp_f32 v63, v63
  v_exp_f32 v64, v64
  v_exp_f32 v65, v65
  v_exp_f32 v66, v66
  v_exp_f32 v67, v67
  v_pk_fma_f32 v[52:53], v[52:53], s[48:49], s[48:49] clamp
  v_pk_fma_f32 v[54:55], v[54:55], s[48:49], s[48:49] clamp
  v_pk_fma_f32 v[56:57], v[56:57], s[48:49], s[48:49] clamp
  v_pk_fma_f32 v[58:59], v[58:59], s[48:49], s[48:49] clamp
  v_pk_fma_f32 v[60:61], v[60:61], s[48:49], s[48:49] clamp
  v_pk_fma_f32 v[62:63], v[62:63], s[48:49], s[48:49] clamp
  v_pk_fma_f32 v[64:65], v[64:65], s[48:49], s[48:49] clamp
  v_pk_fma_f32 v[66:67], v[66:67], s[48:49], s[48:49] clamp
  v_pk_mul_f32 v[248:249], v[52:53], v[54:55]
  v_pk_mul_f32 v[140:141], v[20:21], v[54:55]
  v_rcp_f32 v248, v248
  v_pk_add_f32 v[132:133], v[52:53], v[54:55]
  v_rcp_f32 v249, v249
  v_pk_fma_f32 v[140:141], v[22:23], v[52:53], v[140:141]
  v_pk_mul_f32 v[250:251], v[56:57], v[58:59]
  v_pk_mul_f32 v[142:143], v[24:25], v[58:59]
  v_rcp_f32 v250, v250
  v_pk_add_f32 v[134:135], v[56:57], v[58:59]
  v_rcp_f32 v251, v251
  v_pk_fma_f32 v[142:143], v[26:27], v[56:57], v[142:143]
  v_pk_mul_f32 v[252:253], v[60:61], v[62:63]
  v_pk_mul_f32 v[144:145], v[28:29], v[62:63]
  v_rcp_f32 v252, v252
  v_pk_add_f32 v[136:137], v[60:61], v[62:63]
  v_rcp_f32 v253, v253
  v_pk_fma_f32 v[144:145], v[30:31], v[60:61], v[144:145]
  v_pk_mul_f32 v[254:255], v[64:65], v[66:67]
  v_pk_mul_f32 v[146:147], v[32:33], v[66:67]
  v_rcp_f32 v254, v254
  v_pk_add_f32 v[138:139], v[64:65], v[66:67]
  v_rcp_f32 v255, v255
  v_pk_fma_f32 v[146:147], v[34:35], v[64:65], v[146:147]
  s_setprio 1
  s_barrier
  s_cbranch_scc0 K_loop
K_drain0:
  v_mov_b32 v128, v124
  v_mov_b32 v129, v125
  v_mov_b32 v130, v126
  v_mov_b32 v131, v127
K_drain:
  s_setprio 0
  s_cmp_lg_u32 s36, s61
  s_cbranch_scc1 K_done
  s_barrier
K_done:
  s_bitcmp1_b32 s41, 0
  s_cbranch_scc1 K_half
  v_pk_fma_f32 v[148:149], v[132:133], v[248:249], v[148:149]
  v_pk_fma_f32 v[150:151], v[134:135], v[250:251], v[150:151]
  v_pk_fma_f32 v[152:153], v[136:137], v[252:253], v[152:153]
  v_pk_fma_f32 v[154:155], v[138:139], v[254:255], v[154:155]
  v_pk_fma_f32 v[156:157], v[140:141], v[248:249], v[156:157]
  v_pk_fma_f32 v[158:159], v[142:143], v[250:251], v[158:159]
  v_pk_fma_f32 v[160:161], v[144:145], v[252:253], v[160:161]
  v_pk_fma_f32 v[162:163], v[146:147], v[254:255], v[162:163]
K_last:
  v_cvt_pk_bf16_f32 v164, v148, v149
  v_cvt_pk_bf16_f32 v165, v150, v151
  v_cvt_pk_bf16_f32 v166, v152, v153
  v_cvt_pk_bf16_f32 v167, v154, v155
  v_cvt_pk_bf16_f32 v168, v156, v157
  v_cvt_pk_bf16_f32 v169, v158, v159
  v_cvt_pk_bf16_f32 v170, v160, v161
  v_cvt_pk_bf16_f32 v171, v162, v163
  s_nop 1
  v_mfma_f32_32x32x16_bf16 v[208:223], v[128:131], v[164:167], v[208:223]
  v_mfma_f32_32x32x16_bf16 v[224:239], v[128:131], v[168:171], v[224:239]
  s_cmp_lg_u32 s46, 0
  s_cbranch_scc1 K_again
  v_and_b32 v41, 31, v2
  s_and_b32 s50, s3, 1
  s_lshl_b32 s50, s50, 7
  s_add_u32 s50, s50, s39
  v_lshl_add_u32 v42, v41, 2, s50
  v_and_b32 v40, 32, v2
  v_lshl_add_u32 v42, v40, 5, v42
  s_mov_b32 s50, 0x4d8637bd
  s_mov_b32 s51, s50
  s_mov_b32 s56, 0xffff0000
  v_lshlrev_b32 v64, 16, v192
  v_and_b32 v65, s56, v192
  v_lshlrev_b32 v96, 16, v240
  v_and_b32 v97, s56, v240
  v_lshlrev_b32 v66, 16, v193
  v_and_b32 v67, s56, v193
  v_lshlrev_b32 v98, 16, v241
  v_and_b32 v99, s56, v241
  v_pk_add_f32 v[208:209], v[208:209], s[50:51]
  v_pk_add_f32 v[210:211], v[210:211], s[50:51]
  v_pk_add_f32 v[212:213], v[212:213], s[50:51]
  v_pk_add_f32 v[214:215], v[214:215], s[50:51]
  v_pk_add_f32 v[216:217], v[216:217], s[50:51]
  v_pk_add_f32 v[218:219], v[218:219], s[50:51]
  v_pk_add_f32 v[220:221], v[220:221], s[50:51]
  v_pk_add_f32 v[222:223], v[222:223], s[50:51]
  v_rcp_f32 v208, v208
  v_rcp_f32 v209, v209
  v_rcp_f32 v210, v210
  v_rcp_f32 v211, v211
  v_rcp_f32 v212, v212
  v_rcp_f32 v213, v213
  v_rcp_f32 v214, v214
  v_rcp_f32 v215, v215
  v_rcp_f32 v216, v216
  v_rcp_f32 v217, v217
  v_rcp_f32 v218, v218
  v_rcp_f32 v219, v219
  v_rcp_f32 v220, v220
  v_rcp_f32 v221, v221
  v_rcp_f32 v222, v222
  v_rcp_f32 v223, v223
  s_waitcnt vmcnt(0)
  v_pk_mul_f32 v[208:209], v[208:209], v[224:225]
  ds_write2st64_b32 v42, v208, v209 offset0:0 offset1:1
  v_pk_mul_f32 v[210:211], v[210:211], v[226:227]
  ds_write2st64_b32 v42, v210, v211 offset0:2 offset1:3
  v_pk_mul_f32 v[212:213], v[212:213], v[228:229]
  ds_write2st64_b32 v42, v212, v213 offset0:8 offset1:9
  v_pk_mul_f32 v[214:215], v[214:215], v[230:231]
  ds_write2st64_b32 v42, v214, v215 offset0:10 offset1:11
  v_pk_mul_f32 v[216:217], v[216:217], v[232:233]
  ds_write2st64_b32 v42, v216, v217 offset0:16 offset1:17
  v_pk_mul_f32 v[218:219], v[218:219], v[234:235]
  ds_write2st64_b32 v42, v218, v219 offset0:18 offset1:19
  v_pk_mul_f32 v[220:221], v[220:221], v[236:237]
  ds_write2st64_b32 v42, v220, v221 offset0:24 offset1:25
  v_pk_mul_f32 v[222:223], v[222:223], v[238:239]
  ds_write2st64_b32 v42, v222, v223 offset0:26 offset1:27
  v_lshlrev_b32 v68, 16, v194
  v_and_b32 v69, s56, v194
  v_lshlrev_b32 v100, 16, v242
  v_and_b32 v101, s56, v242
  v_lshlrev_b32 v70, 16, v195
  v_and_b32 v71, s56, v195
  v_lshlrev_b32 v102, 16, v243
  v_and_b32 v103, s56, v243
  v_lshlrev_b32 v72, 16, v196
  v_and_b32 v73, s56, v196
  v_lshlrev_b32 v104, 16, v244
  v_and_b32 v105, s56, v244
  v_lshlrev_b32 v74, 16, v197
  v_and_b32 v75, s56, v197
  v_lshlrev_b32 v106, 16, v245
  v_and_b32 v107, s56, v245
  v_lshlrev_b32 v76, 16, v198
  v_and_b32 v77, s56, v198
  v_lshlrev_b32 v108, 16, v246
  v_and_b32 v109, s56, v246
  v_lshlrev_b32 v78, 16, v199
  v_and_b32 v79, s56, v199
  v_lshlrev_b32 v110, 16, v247
  v_and_b32 v111, s56, v247
  v_lshrrev_b32 v44, 4, v0
  v_bfe_u32 v45, v0, 2, 2
  v_lshlrev_b32 v45, 13, v45
  v_lshl_add_u32 v45, v44, 8, v45
  v_and_b32 v46, 7, v0
  v_lshl_add_u32 v45, v46, 5, v45
  v_add_u32 v45, 98304, v45
  v_add_u32 v46, 0x8000, v45
  v_cmp_gt_u32 vcc, s43, v44
  v_lshlrev_b32 v43, 4, v0
  s_movk_i32 s51, 8192
  v_cndmask_b32 v45, v46, v45, vcc
  s_waitcnt lgkmcnt(0)
  s_barrier
  ds_read_b128 v[48:51], v45
  ds_read_b128 v[52:55], v45 offset:16
  ds_read_b128 v[56:59], v46
  ds_read_b128 v[60:63], v46 offset:16
  v_pk_add_f32 v[96:97], v[96:97], v[64:65]
  v_pk_add_f32 v[98:99], v[98:99], v[66:67]
  v_pk_add_f32 v[100:101], v[100:101], v[68:69]
  v_pk_add_f32 v[102:103], v[102:103], v[70:71]
  v_pk_add_f32 v[104:105], v[104:105], v[72:73]
  v_pk_add_f32 v[106:107], v[106:107], v[74:75]
  v_pk_add_f32 v[108:109], v[108:109], v[76:77]
  v_pk_add_f32 v[110:111], v[110:111], v[78:79]
  s_waitcnt lgkmcnt(2)
  v_pk_add_f32 v[48:49], v[48:49], v[96:97]
  v_pk_add_f32 v[50:51], v[50:51], v[98:99]
  v_pk_add_f32 v[52:53], v[52:53], v[100:101]
  v_pk_add_f32 v[54:55], v[54:55], v[102:103]
  v_max_f32 v48, v64, v48
  v_max_f32 v49, v65, v49
  v_max_f32 v50, v66, v50
  v_max_f32 v51, v67, v51
  v_max_f32 v52, v68, v52
  v_max_f32 v53, v69, v53
  v_max_f32 v54, v70, v54
  v_max_f32 v55, v71, v55
  v_cvt_pk_bf16_f32 v80, v48, v49
  v_cvt_pk_bf16_f32 v81, v50, v51
  v_cvt_pk_bf16_f32 v82, v52, v53
  v_cvt_pk_bf16_f32 v83, v54, v55
  buffer_store_dwordx4 v[80:83], v43, s[32:35], 0 offen sc1
  s_waitcnt lgkmcnt(0)
  v_pk_add_f32 v[56:57], v[56:57], v[104:105]
  v_pk_add_f32 v[58:59], v[58:59], v[106:107]
  v_pk_add_f32 v[60:61], v[60:61], v[108:109]
  v_pk_add_f32 v[62:63], v[62:63], v[110:111]
  v_max_f32 v56, v72, v56
  v_max_f32 v57, v73, v57
  v_max_f32 v58, v74, v58
  v_max_f32 v59, v75, v59
  v_max_f32 v60, v76, v60
  v_max_f32 v61, v77, v61
  v_max_f32 v62, v78, v62
  v_max_f32 v63, v79, v63
  v_cvt_pk_bf16_f32 v84, v56, v57
  v_cvt_pk_bf16_f32 v85, v58, v59
  v_cvt_pk_bf16_f32 v86, v60, v61
  v_cvt_pk_bf16_f32 v87, v62, v63
  buffer_store_dwordx4 v[84:87], v43, s[32:35], s51 offen sc1
K_end:
  s_endpgm
K_half:
  v_pk_mul_f32 v[148:149], v[132:133], v[248:249]
  v_pk_mul_f32 v[150:151], v[134:135], v[250:251]
  v_pk_mul_f32 v[152:153], v[136:137], v[252:253]
  v_pk_mul_f32 v[154:155], v[138:139], v[254:255]
  v_pk_mul_f32 v[156:157], v[140:141], v[248:249]
  v_pk_mul_f32 v[158:159], v[142:143], v[250:251]
  v_pk_mul_f32 v[160:161], v[144:145], v[252:253]
  v_pk_mul_f32 v[162:163], v[146:147], v[254:255]
  s_branch K_last
K_clr:
  s_waitcnt lgkmcnt(0)
  s_mov_b32 s20, s52
  s_mov_b32 s21, s53
  s_mov_b32 s12, s78
  s_mov_b32 s13, s79
  s_mov_b32 s14, 20971520
  s_mov_b32 s15, 0x20000
  s_mov_b32 s28, s76
  s_mov_b32 s29, s77
  s_movk_i32 s30, 256
  s_mov_b32 s31, 0x20000
  v_mov_b32 v8, 0
  v_mov_b32 v9, 0
  v_mov_b32 v10, 0
  v_mov_b32 v11, 0
  v_lshlrev_b32 v4, 7, v2
  s_mov_b32 s50, 10485760
  buffer_store_dwordx4 v[8:11], v4, s[12:15], s50 offen sc1
  s_add_u32 m0, s90, 48128
  s_sub_u32 s50, s51, 12544
  buffer_load_dwordx4 v3, s[20:23], s50 offen lds
  s_add_u32 m0, s90, 56320
  s_sub_u32 s50, s91, 12544
  buffer_load_dwordx4 v3, s[20:23], s50 offen lds
  s_add_u32 m0, s90, 81920
  s_sub_u32 s50, s51, 0
  buffer_load_dwordx4 v3, s[20:23], s50 offen lds
  s_add_u32 m0, s90, 90112
  s_sub_u32 s50, s91, 0
  buffer_load_dwordx4 v3, s[20:23], s50 offen lds
  v_and_b32 v12, 4, v2
  v_cmp_eq_u32 vcc, 0, v12
  v_mov_b32 v13, 0x71807180
  v_and_b32 v5, 0x1f0, v1
  v_cndmask_b32 v12, 0, v13, vcc
  v_mov_b32 v13, v12
  v_mov_b32 v14, v12
  v_mov_b32 v15, v12
  s_mov_b32 s50, 1048064
  buffer_store_dwordx4 v[12:15], v5, s[12:15], s50 offen sc1
  s_branch K_np1
K_pub:
  s_mov_b64 exec, 1
  s_waitcnt vmcnt(8)
  buffer_store_dword v206, off, s[28:31], 0 sc1
  s_mov_b64 exec, -1
  s_waitcnt vmcnt(4)
  s_branch K_np2
K_prod:
  s_lshl_b32 s50, s3, 3
  s_mov_b32 s92, 0x38204028
  s_mov_b32 s93, 0x48085830
  s_lshr_b64 s[92:93], s[92:93], s50
  s_and_b32 s92, s92, 0xff
  s_load_dwordx2 s[96:97], s[0:1], s92
  s_mov_b32 s20, s52
  s_mov_b32 s21, s53
  v_lshlrev_b32 v4, 2, v0
  v_mov_b32 v62, 0
  ds_write_b32 v4, v62
  v_mov_b32 v40, -1
  v_mov_b32 v41, -1
  v_mov_b32 v42, -1
  v_mov_b32 v43, -1
  ds_write_b128 v1, v[40:43] offset:4096
  ds_write_b128 v1, v[40:43] offset:12288
  ds_write_b128 v1, v[40:43] offset:20480
  ds_write_b128 v1, v[40:43] offset:28672
  v_mov_b32 v5, 128
  v_writelane_b32 v5, 16, 4
  s_mov_b32 s50, 81920
  v_writelane_b32 v5, s50, 5
  s_mov_b32 s50, 50000
  v_writelane_b32 v5, s50, 6
  s_mov_b32 s50, 12500
  v_writelane_b32 v5, s50, 7
  s_and_b32 s93, s2, 0xf0
  v_readlane_b32 s50, v5, s3
  v_add_u32 v4, s93, v85
  s_waitcnt lgkmcnt(0)
  v_mul_u32_u24 v4, s50, v4
  s_barrier
  s_add_u32 m0, s90, 81920
  s_sub_u32 s50, s51, 0
  buffer_load_dwordx4 v3, s[20:23], s50 offen lds
  s_add_u32 m0, s90, 90112
  s_sub_u32 s50, s91, 0
  buffer_load_dwordx4 v3, s[20:23], s50 offen lds
  s_mov_b64 exec, 0xffff
  global_load_dword v60, v4, s[96:97] sc1
  s_mov_b64 exec, -1
  s_sub_u32 s90, s82, s88
  v_add_u32 v4, 8192, v1
  v_cmp_gt_u32 s[92:93], s90, v4
  s_mov_b32 s91, 4294967247
  v_mov_b32 v6, 4
  v_lshlrev_b32 v7, 22, v0
  v_mov_b32 v36, 0
  v_mov_b32 v37, 0
  v_mov_b32 v38, 0
  v_mov_b32 v39, 0
  v_add_u32 v68, 0x0, v7
  v_add_u32 v69, 0x100000, v7
  v_add_u32 v70, 0x200000, v7
  v_add_u32 v71, 0x300000, v7
  v_add_u32 v72, 0x80000000, v7
  v_add_u32 v73, 0x80100000, v7
  v_add_u32 v74, 0x80200000, v7
  v_add_u32 v75, 0x80300000, v7
  s_waitcnt vmcnt(6)
  v_mul_u32_u24 v44, 21400, v8
  v_lshrrev_b32 v44, 20, v44
  v_lshlrev_b32 v24, 2, v44
  v_mul_u32_u24 v45, 21400, v9
  v_lshrrev_b32 v45, 20, v45
  v_lshlrev_b32 v25, 2, v45
  v_mul_u32_u24 v46, 21400, v10
  v_lshrrev_b32 v46, 20, v46
  v_lshlrev_b32 v26, 2, v46
  v_mul_u32_u24 v47, 21400, v11
  v_lshrrev_b32 v47, 20, v47
  v_lshlrev_b32 v27, 2, v47
  ds_add_rtn_u32 v32, v24, v6
  ds_add_rtn_u32 v33, v25, v6
  ds_add_rtn_u32 v34, v26, v6
  ds_add_rtn_u32 v35, v27, v6
  s_waitcnt vmcnt(5)
  v_mul_u32_u24 v48, 21400, v12
  v_lshrrev_b32 v48, 20, v48
  v_lshlrev_b32 v28, 2, v48
  v_mul_u32_u24 v49, 21400, v13
  v_lshrrev_b32 v49, 20, v49
  v_lshlrev_b32 v29, 2, v49
  v_mul_u32_u24 v50, 21400, v14
  v_lshrrev_b32 v50, 20, v50
  v_lshlrev_b32 v30, 2, v50
  v_mul_u32_u24 v51, 21400, v15
  v_lshrrev_b32 v51, 20, v51
  v_lshlrev_b32 v31, 2, v51
  s_mov_b64 exec, s[92:93]
  ds_add_rtn_u32 v36, v28, v6
  ds_add_rtn_u32 v37, v29, v6
  ds_add_rtn_u32 v38, v30, v6
  ds_add_rtn_u32 v39, v31, v6
  s_mov_b64 exec, -1
  s_lshl_b32 s56, s62, 7
  s_add_u32 s56, s56, 16777216
  s_add_u32 s57, s56, 1048576
  s_add_u32 s58, s56, 2097152
  s_add_u32 s59, s56, 3145728
  v_lshrrev_b32 v5, 3, v0
  v_and_b32 v61, 0x70, v1
  v_lshl_add_u32 v61, v5, 14, v61
  s_mov_b32 s4, s78
  s_mov_b32 s5, s79
  s_mov_b32 s12, s78
  s_mov_b32 s13, s79
  s_mov_b32 s14, 20971520
  s_mov_b32 s15, 0x20000
  s_waitcnt vmcnt(3)
  v_mad_i32_i24 v8, v44, s91, v8
  v_and_b32 v4, 7, v16
  v_lshl_or_b32 v8, v8, 3, v4
  v_lshrrev_b32 v16, 3, v16
  v_lshl_or_b32 v8, v8, 11, v68
  v_or_b32 v16, v8, v16
  v_mad_i32_i24 v9, v45, s91, v9
  v_and_b32 v4, 7, v17
  v_lshl_or_b32 v9, v9, 3, v4
  v_lshrrev_b32 v17, 3, v17
  v_lshl_or_b32 v9, v9, 11, v69
  v_or_b32 v17, v9, v17
  v_mad_i32_i24 v10, v46, s91, v10
  v_and_b32 v4, 7, v18
  v_lshl_or_b32 v10, v10, 3, v4
  v_lshrrev_b32 v18, 3, v18
  v_lshl_or_b32 v10, v10, 11, v70
  v_or_b32 v18, v10, v18
  v_mad_i32_i24 v11, v47, s91, v11
  v_and_b32 v4, 7, v19
  v_lshl_or_b32 v11, v11, 3, v4
  v_lshrrev_b32 v19, 3, v19
  v_lshl_or_b32 v11, v11, 11, v71
  v_or_b32 v19, v11, v19
  v_mad_i32_i24 v12, v48, s91, v12
  v_and_b32 v4, 7, v20
  v_lshl_or_b32 v12, v12, 3, v4
  v_lshrrev_b32 v20, 3, v20
  v_lshl_or_b32 v12, v12, 11, v72
  v_or_b32 v20, v12, v20
  v_mad_i32_i24 v13, v49, s91, v13
  v_and_b32 v4, 7, v21
  v_lshl_or_b32 v13, v13, 3, v4
  v_lshrrev_b32 v21, 3, v21
  v_lshl_or_b32 v13, v13, 11, v73
  v_or_b32 v21, v13, v21
  v_mad_i32_i24 v14, v50, s91, v14
  v_and_b32 v4, 7, v22
  v_lshl_or_b32 v14, v14, 3, v4
  v_lshrrev_b32 v22, 3, v22
  v_lshl_or_b32 v14, v14, 11, v74
  v_or_b32 v22, v14, v22
  v_mad_i32_i24 v15, v51, s91, v15
  v_and_b32 v4, 7, v23
  v_lshl_or_b32 v15, v15, 3, v4
  v_lshrrev_b32 v23, 3, v23
  v_lshl_or_b32 v15, v15, 11, v75
  v_or_b32 v23, v15, v23
  s_waitcnt lgkmcnt(0)
  v_add_u32 v4, v32, v24
  v_and_b32 v4, 0x7f, v4
  v_lshl_add_u32 v44, v24, 5, v4
  ds_write_b32 v44, v16 offset:4096
  v_add_u32 v4, v33, v25
  v_and_b32 v4, 0x7f, v4
  v_lshl_add_u32 v45, v25, 5, v4
  ds_write_b32 v45, v17 offset:4096
  v_add_u32 v4, v34, v26
  v_and_b32 v4, 0x7f, v4
  v_lshl_add_u32 v46, v26, 5, v4
  ds_write_b32 v46, v18 offset:4096
  v_add_u32 v4, v35, v27
  v_and_b32 v4, 0x7f, v4
  v_lshl_add_u32 v47, v27, 5, v4
  ds_write_b32 v47, v19 offset:4096
  s_mov_b64 exec, s[92:93]
  v_add_u32 v4, v36, v28
  v_and_b32 v4, 0x7f, v4
  v_lshl_add_u32 v48, v28, 5, v4
  ds_write_b32 v48, v20 offset:4096
  v_add_u32 v4, v37, v29
  v_and_b32 v4, 0x7f, v4
  v_lshl_add_u32 v49, v29, 5, v4
  ds_write_b32 v49, v21 offset:4096
  v_add_u32 v4, v38, v30
  v_and_b32 v4, 0x7f, v4
  v_lshl_add_u32 v50, v30, 5, v4
  ds_write_b32 v50, v22 offset:4096
  v_add_u32 v4, v39, v31
  v_and_b32 v4, 0x7f, v4
  v_lshl_add_u32 v51, v31, 5, v4
  ds_write_b32 v51, v23 offset:4096
  s_mov_b64 exec, -1
  v_or3_b32 v4, v32, v33, v34
  v_or3_b32 v5, v35, v36, v37
  v_or3_b32 v4, v4, v38, v39
  v_or_b32 v4, v4, v5
  v_cmp_lt_u32 vcc, 0x7f, v4
  s_mov_b64 exec, vcc
  ds_write_b32 v62, v6 offset:1024
  s_mov_b64 exec, -1
  s_waitcnt vmcnt(1) lgkmcnt(0)
  s_barrier
  ds_read_b32 v4, v62 offset:1024
  ds_read_b128 v[8:11], v1 offset:4096
  ds_read_b128 v[12:15], v1 offset:12288
  ds_read_b128 v[68:71], v1 offset:20480
  ds_read_b128 v[72:75], v1 offset:28672
  s_waitcnt lgkmcnt(4)
  v_readfirstlane_b32 s50, v4
  s_cmp_lg_u32 s50, 0
  s_cbranch_scc1 K_slow
K_out:
  s_waitcnt lgkmcnt(3)
  buffer_store_dwordx4 v[8:11], v61, s[12:15], s56 offen sc1
  s_waitcnt lgkmcnt(2)
  buffer_store_dwordx4 v[12:15], v61, s[12:15], s57 offen sc1
  s_waitcnt lgkmcnt(1)
  buffer_store_dwordx4 v[68:71], v61, s[12:15], s58 offen sc1
  s_waitcnt lgkmcnt(0)
  buffer_store_dwordx4 v[72:75], v61, s[12:15], s59 offen sc1
  s_lshl_b32 s39, s3, 13
  s_add_u32 s39, s39, 98304
  s_lshl_b32 s63, s37, 6
  s_cmp_eq_u32 s36, 0
  s_cselect_b32 s64, s64, s70
  s_cselect_b32 s65, s65, s71
  s_cselect_b32 s66, s66, s72
  s_cselect_b32 s67, s67, s73
  s_mov_b32 s24, s64
  s_mov_b32 s25, s65
  s_mov_b32 s26, 32768
  s_mov_b32 s27, 0x20000
  s_mov_b32 s32, s68
  s_mov_b32 s33, s69
  s_mov_b32 s34, 4096
  s_mov_b32 s35, 0x20000
  s_mov_b32 s14, 20971520
  s_mov_b32 s15, 0x20000
  s_movk_i32 s30, 256
  s_mov_b32 s31, 0x20000
  s_mov_b32 s4, s78
  s_mov_b32 s5, s79
  s_mov_b32 s12, s78
  s_mov_b32 s13, s79
  s_mov_b32 s10, s74
  s_mov_b32 s11, s75
  s_mov_b32 s28, s76
  s_mov_b32 s29, s77
  v_lshrrev_b32 v88, 5, v2
  v_and_b32 v89, 31, v2
  v_lshrrev_b32 v90, 2, v85
  v_lshl_add_u32 v90, v88, 3, v90
  v_and_b32 v91, 1, v84
  v_lshlrev_b32 v91, 5, v91
  v_lshl_add_u32 v91, v87, 3, v91
  v_lshl_add_u32 v90, v90, 6, v91
  v_add_u32 v169, s39, v90
  s_lshl_b32 s50, s37, 10
  s_add_u32 s50, s50, 77824
  v_add_u32 v164, s50, v90
  v_xor_b32 v90, v88, v85
  v_lshlrev_b32 v90, 4, v90
  v_lshl_add_u32 v170, v89, 8, v90
  v_lshlrev_b32 v93, 3, v88
  v_lshrrev_b32 v94, 4, v0
  v_xor_b32 v90, v94, v0
  v_and_b32 v90, 15, v90
  v_lshlrev_b32 v90, 4, v90
  v_lshl_add_u32 v191, v94, 8, v90
  s_mov_b32 s94, 0xbfb8aa3b
  s_mov_b32 s95, 0xbfb8aa3b
  s_lshr_b32 s50, s62, 2
  s_lshl_b32 s50, s50, 7
  s_and_b32 s97, s2, 3
  s_lshl_b32 s97, s97, 2
  s_add_u32 s97, s97, s50
  s_cmp_eq_u32 s3, 0
  s_cselect_b32 s97, s97, 117440512
  s_cselect_b32 s6, 0, 117440512
  buffer_load_dword v99, off, s[28:31], s6 sc1
  s_lshl_b32 s89, s37, 10
  s_add_u32 m0, s89, 77824
  s_nop 0
  buffer_load_dwordx4 v168, s[32:35], s63 offen lds
  s_add_u32 m0, s39, 0
  s_add_u32 s89, s63, 0
  buffer_load_dwordx4 v168, s[24:27], s89 offen lds
  s_add_u32 m0, s39, 1024
  s_add_u32 s89, s63, 4096
  buffer_load_dwordx4 v168, s[24:27], s89 offen lds
  v_add_u32 v170, 81920, v170
  v_xor_b32 v3, 0, v170
  ds_read_b128 v[100:103], v3 offset:0
  ds_read_b128 v[104:107], v3 offset:8192
  v_xor_b32 v3, 32, v170
  ds_read_b128 v[108:111], v3 offset:0
  ds_read_b128 v[112:115], v3 offset:8192
  v_xor_b32 v3, 64, v170
  ds_read_b128 v[116:119], v3 offset:0
  ds_read_b128 v[120:123], v3 offset:8192
  v_xor_b32 v3, 96, v170
  ds_read_b128 v[124:127], v3 offset:0
  ds_read_b128 v[128:131], v3 offset:8192
  v_xor_b32 v3, 128, v170
  ds_read_b128 v[132:135], v3 offset:0
  ds_read_b128 v[136:139], v3 offset:8192
  v_xor_b32 v3, 160, v170
  ds_read_b128 v[140:143], v3 offset:0
  ds_read_b128 v[144:147], v3 offset:8192
  v_xor_b32 v3, 192, v170
  ds_read_b128 v[148:151], v3 offset:0
  ds_read_b128 v[152:155], v3 offset:8192
  v_xor_b32 v3, 224, v170
  ds_read_b128 v[156:159], v3 offset:0
  ds_read_b128 v[160:163], v3 offset:8192
  v_add_u32 v3, 81920, v191
  ds_read_b128 v[192:195], v3
  ds_read_b128 v[196:199], v3 offset:8192
  s_add_u32 s96, s97, 10489856
  s_mov_b32 s97, 117440512
  s_waitcnt vmcnt(3)
  s_cmp_lg_u32 s3, 0
  s_cbranch_scc1 K_rp
  s_mov_b32 s50, 0
K_rp_spin:
  v_cmp_eq_u32 vcc, 0, v99
  s_cbranch_vccz K_rp
  buffer_load_dword v99, off, s[28:31], s6 sc1
  s_add_u32 s50, s50, 1
  s_cmp_lt_u32 s50, 0x40000
  s_waitcnt vmcnt(0)
  s_cbranch_scc1 K_rp_spin
K_rp:
  s_mov_b64 exec, 1
  s_barrier
  buffer_store_dword v206, off, s[12:15], s96 sc1
  s_mov_b64 exec, -1
  s_add_u32 m0, s39, 2048
  s_add_u32 s89, s63, 8192
  buffer_load_dwordx4 v168, s[24:27], s89 offen lds
  s_add_u32 m0, s39, 3072
  s_add_u32 s89, s63, 12288
  buffer_load_dwordx4 v168, s[24:27], s89 offen lds
  s_add_u32 m0, s39, 4096
  s_add_u32 s89, s63, 16384
  buffer_load_dwordx4 v168, s[24:27], s89 offen lds
  s_add_u32 m0, s39, 5120
  s_add_u32 s89, s63, 20480
  buffer_load_dwordx4 v168, s[24:27], s89 offen lds
  s_add_u32 m0, s39, 6144
  s_add_u32 s89, s63, 24576
  buffer_load_dwordx4 v168, s[24:27], s89 offen lds
  s_add_u32 m0, s39, 7168
  s_add_u32 s89, s63, 28672
  buffer_load_dwordx4 v168, s[24:27], s89 offen lds
  s_mov_b32 s16, s54
  s_mov_b32 s17, s55
  s_mov_b32 s18, 12800000
  s_mov_b32 s19, 0x20000
  s_mul_i32 s50, s3, 5120
  s_mul_i32 s51, s62, 100096
  s_add_u32 s50, s50, s51
  s_add_u32 s50, s50, 0
  v_lshlrev_b32 v98, 7, v2
  s_bfm_b64 exec, 40, 0
  buffer_load_dword v201, v98, s[16:19], s50 offen
  s_mov_b64 exec, -1
  v_lshlrev_b32 v76, 2, v0
  v_mov_b32 v77, 0
  ds_write_b32 v76, v77
  v_mov_b32 v76, 0x6e4007ff
  v_mov_b32 v77, 117440512
  v_mov_b32 v78, v76
  v_mov_b32 v79, v77
  v_lshlrev_b32 v80, 4, v0
  ds_write_b128 v80, v[76:79] offset:7168
  ds_write_b128 v80, v[76:79] offset:15360
  ds_write_b128 v80, v[76:79] offset:23552
  ds_write_b128 v80, v[76:79] offset:31744
  ds_write_b128 v80, v[76:79] offset:39936
  s_waitcnt vmcnt(9)
  ds_read_b64_tr_b16 v[166:167], v164 offset:256
  ds_read_b64_tr_b16 v[164:165], v164
  ds_read_b64_tr_b16 v[208:209], v169 offset:0
  ds_read_b64_tr_b16 v[210:211], v169 offset:256
  s_waitcnt vmcnt(8)
  ds_read_b64_tr_b16 v[212:213], v169 offset:1024
  ds_read_b64_tr_b16 v[214:215], v169 offset:1280
  s_waitcnt lgkmcnt(2)
  v_mfma_f32_32x32x16_bf16 v[4:19], v[208:211], v[100:103], 0
  v_mfma_f32_32x32x16_bf16 v[20:35], v[208:211], v[104:107], 0
  s_waitcnt vmcnt(6)
  ds_read_b64_tr_b16 v[216:217], v169 offset:2048
  ds_read_b64_tr_b16 v[218:219], v169 offset:2304
  s_waitcnt lgkmcnt(2)
  v_mfma_f32_32x32x16_bf16 v[4:19], v[212:215], v[108:111], v[4:19]
  v_mfma_f32_32x32x16_bf16 v[20:35], v[212:215], v[112:115], v[20:35]
  s_waitcnt vmcnt(5)
  ds_read_b64_tr_b16 v[220:221], v169 offset:3072
  ds_read_b64_tr_b16 v[222:223], v169 offset:3328
  s_waitcnt lgkmcnt(2)
  v_mfma_f32_32x32x16_bf16 v[4:19], v[216:219], v[116:119], v[4:19]
  v_mfma_f32_32x32x16_bf16 v[20:35], v[216:219], v[120:123], v[20:35]
  s_waitcnt vmcnt(4)
  ds_read_b64_tr_b16 v[224:225], v169 offset:4096
  ds_read_b64_tr_b16 v[226:227], v169 offset:4352
  s_waitcnt lgkmcnt(2)
  v_mfma_f32_32x32x16_bf16 v[4:19], v[220:223], v[124:127], v[4:19]
  v_mfma_f32_32x32x16_bf16 v[20:35], v[220:223], v[128:131], v[20:35]
  s_waitcnt vmcnt(3)
  ds_read_b64_tr_b16 v[228:229], v169 offset:5120
  ds_read_b64_tr_b16 v[230:231], v169 offset:5376
  s_waitcnt lgkmcnt(2)
  v_mfma_f32_32x32x16_bf16 v[4:19], v[224:227], v[132:135], v[4:19]
  v_mfma_f32_32x32x16_bf16 v[20:35], v[224:227], v[136:139], v[20:35]
  s_waitcnt vmcnt(2)
  ds_read_b64_tr_b16 v[232:233], v169 offset:6144
  ds_read_b64_tr_b16 v[234:235], v169 offset:6400
  s_waitcnt lgkmcnt(2)
  v_mfma_f32_32x32x16_bf16 v[4:19], v[228:231], v[140:143], v[4:19]
  v_mfma_f32_32x32x16_bf16 v[20:35], v[228:231], v[144:147], v[20:35]
  s_waitcnt vmcnt(1)
  ds_read_b64_tr_b16 v[236:237], v169 offset:7168
  ds_read_b64_tr_b16 v[238:239], v169 offset:7424
  s_waitcnt lgkmcnt(2)
  v_mfma_f32_32x32x16_bf16 v[4:19], v[232:235], v[148:151], v[4:19]
  v_mfma_f32_32x32x16_bf16 v[20:35], v[232:235], v[152:155], v[20:35]
  s_waitcnt lgkmcnt(0)
  v_mfma_f32_32x32x16_bf16 v[4:19], v[236:239], v[156:159], v[4:19]
  v_mfma_f32_32x32x16_bf16 v[20:35], v[236:239], v[160:163], v[20:35]
  s_branch K_join
K_slow:
  v_lshlrev_b32 v5, 4, v2
  s_waitcnt lgkmcnt(0)
  ds_read_b128 v[8:11], v5
  s_waitcnt lgkmcnt(0)
  v_add_u32 v13, v8, v9
  v_add_u32 v14, v13, v10
  v_add_u32 v15, v14, v11
  v_mov_b32 v4, v15
  s_nop 1
  v_add_u32_dpp v4, v4, v4 row_shr:1 row_mask:0xf bank_mask:0xf
  s_nop 1
  v_add_u32_dpp v4, v4, v4 row_shr:2 row_mask:0xf bank_mask:0xf
  s_nop 1
  v_add_u32_dpp v4, v4, v4 row_shr:4 row_mask:0xf bank_mask:0xf
  s_nop 1
  v_add_u32_dpp v4, v4, v4 row_shr:8 row_mask:0xf bank_mask:0xf
  s_nop 1
  v_add_u32_dpp v4, v4, v4 row_bcast:15 row_mask:0xa bank_mask:0xf
  s_nop 1
  v_add_u32_dpp v4, v4, v4 row_bcast:31 row_mask:0xc bank_mask:0xf
  v_sub_u32 v40, v4, v15
  v_add_u32 v41, v40, v8
  v_add_u32 v42, v40, v13
  v_add_u32 v43, v40, v14
  ds_write_b128 v5, v[40:43] offset:2048
  ds_read_b32 v24, v24 offset:2048
  ds_read_b32 v25, v25 offset:2048
  ds_read_b32 v26, v26 offset:2048
  ds_read_b32 v27, v27 offset:2048
  ds_read_b32 v28, v28 offset:2048
  ds_read_b32 v29, v29 offset:2048
  ds_read_b32 v30, v30 offset:2048
  ds_read_b32 v31, v31 offset:2048
  s_waitcnt lgkmcnt(0)
  s_mov_b64 exec, -1
  v_add_u32 v24, v24, v32
  ds_write_b32 v24, v16 offset:36864
  v_cmp_gt_u32 vcc, 0x80, v32
  s_mov_b64 exec, vcc
  ds_write_b32 v44, v16 offset:4096
  s_mov_b64 exec, -1
  v_add_u32 v25, v25, v33
  ds_write_b32 v25, v17 offset:36864
  v_cmp_gt_u32 vcc, 0x80, v33
  s_mov_b64 exec, vcc
  ds_write_b32 v45, v17 offset:4096
  s_mov_b64 exec, -1
  v_add_u32 v26, v26, v34
  ds_write_b32 v26, v18 offset:36864
  v_cmp_gt_u32 vcc, 0x80, v34
  s_mov_b64 exec, vcc
  ds_write_b32 v46, v18 offset:4096
  s_mov_b64 exec, -1
  v_add_u32 v27, v27, v35
  ds_write_b32 v27, v19 offset:36864
  v_cmp_gt_u32 vcc, 0x80, v35
  s_mov_b64 exec, vcc
  ds_write_b32 v47, v19 offset:4096
  s_mov_b64 exec, s[92:93]
  v_add_u32 v28, v28, v36
  ds_write_b32 v28, v20 offset:36864
  v_cmp_gt_u32 vcc, 0x80, v36
  s_mov_b64 exec, vcc
  ds_write_b32 v48, v20 offset:4096
  s_mov_b64 exec, s[92:93]
  v_add_u32 v29, v29, v37
  ds_write_b32 v29, v21 offset:36864
  v_cmp_gt_u32 vcc, 0x80, v37
  s_mov_b64 exec, vcc
  ds_write_b32 v49, v21 offset:4096
  s_mov_b64 exec, s[92:93]
  v_add_u32 v30, v30, v38
  ds_write_b32 v30, v22 offset:36864
  v_cmp_gt_u32 vcc, 0x80, v38
  s_mov_b64 exec, vcc
  ds_write_b32 v50, v22 offset:4096
  s_mov_b64 exec, s[92:93]
  v_add_u32 v31, v31, v39
  ds_write_b32 v31, v23 offset:36864
  v_cmp_gt_u32 vcc, 0x80, v39
  s_mov_b64 exec, vcc
  ds_write_b32 v51, v23 offset:4096
  s_mov_b64 exec, -1
  s_waitcnt lgkmcnt(0)
  s_barrier
  v_mov_b32 v16, 1015808
  v_add_u32 v12, 0, v5
  v_add_u32 v13, 124, v12
  v_and_b32 v13, 0x7f, v13
  v_lshl_add_u32 v13, v12, 5, v13
  v_add_u32 v14, 120, v40
  v_lshl_or_b32 v14, v14, 18, v16
  v_add_u32 v15, -124, v8
  v_cmp_lt_u32 vcc, 0x80, v8
  s_mov_b64 exec, vcc
  ds_write_b32 v13, v14 offset:4096
  ds_write_b32 v40, v15 offset:36984
  s_mov_b64 exec, -1
  v_add_u32 v12, 4, v5
  v_add_u32 v13, 124, v12
  v_and_b32 v13, 0x7f, v13
  v_lshl_add_u32 v13, v12, 5, v13
  v_add_u32 v14, 120, v41
  v_lshl_or_b32 v14, v14, 18, v16
  v_add_u32 v15, -124, v9
  v_cmp_lt_u32 vcc, 0x80, v9
  s_mov_b64 exec, vcc
  ds_write_b32 v13, v14 offset:4096
  ds_write_b32 v41, v15 offset:36984
  s_mov_b64 exec, -1
  v_add_u32 v12, 8, v5
  v_add_u32 v13, 124, v12
  v_and_b32 v13, 0x7f, v13
  v_lshl_add_u32 v13, v12, 5, v13
  v_add_u32 v14, 120, v42
  v_lshl_or_b32 v14, v14, 18, v16
  v_add_u32 v15, -124, v10
  v_cmp_lt_u32 vcc, 0x80, v10
  s_mov_b64 exec, vcc
  ds_write_b32 v13, v14 offset:4096
  ds_write_b32 v42, v15 offset:36984
  s_mov_b64 exec, -1
  v_add_u32 v12, 12, v5
  v_add_u32 v13, 124, v12
  v_and_b32 v13, 0x7f, v13
  v_lshl_add_u32 v13, v12, 5, v13
  v_add_u32 v14, 120, v43
  v_lshl_or_b32 v14, v14, 18, v16
  v_add_u32 v15, -124, v11
  v_cmp_lt_u32 vcc, 0x80, v11
  s_mov_b64 exec, vcc
  ds_write_b32 v13, v14 offset:4096
  ds_write_b32 v43, v15 offset:36984
  s_mov_b64 exec, -1
  ds_read_b128 v[16:19], v1 offset:36864
  ds_read_b128 v[20:23], v1 offset:45056
  s_add_u32 s50, s88, 8388608
  s_add_u32 s80, s4, s50
  s_addc_u32 s81, s5, 0
  s_mov_b32 s82, s90
  s_movk_i32 s50, 8192
  s_waitcnt lgkmcnt(0)
  buffer_store_dwordx4 v[16:19], v1, s[80:83], 0 offen sc1
  buffer_store_dwordx4 v[20:23], v1, s[80:83], s50 offen sc1
  ds_read_b128 v[8:11], v1 offset:4096
  ds_read_b128 v[12:15], v1 offset:12288
  ds_read_b128 v[68:71], v1 offset:20480
  ds_read_b128 v[72:75], v1 offset:28672
  s_branch K_out
K_again:
  s_waitcnt vmcnt(0) lgkmcnt(0)
  s_barrier
  v_lshlrev_b32 v76, 2, v0
  v_mov_b32 v77, 0
  ds_write_b32 v76, v77
  v_mov_b32 v76, 0x6e4007ff
  v_mov_b32 v77, 117440512
  v_mov_b32 v78, v76
  v_mov_b32 v79, v77
  v_lshlrev_b32 v80, 4, v0
  ds_write_b128 v80, v[76:79] offset:7168
  ds_write_b128 v80, v[76:79] offset:15360
  ds_write_b128 v80, v[76:79] offset:23552
  ds_write_b128 v80, v[76:79] offset:31744
  ds_write_b128 v80, v[76:79] offset:39936
  s_cmp_eq_u32 s7, 3
  s_cbranch_scc1 K_next
  buffer_load_dwordx4 v[36:39], v200, s[12:15], s44 offen sc1
  buffer_load_dwordx4 v[40:43], v200, s[12:15], s44 offen offset:64 sc1
  s_waitcnt vmcnt(0)
  s_cmp_eq_u32 s7, 1
  s_cbranch_scc0 K_marks
  s_mov_b32 s7, 2
  s_mov_b64 s[56:57], 0
  s_movk_i32 s51, 2016
  s_movk_i32 s50, 2044
  v_lshrrev_b32 v48, 9, v40
  v_and_b32 v48, s50, v48
  v_cmp_gt_u32 s[72:73], s51, v48
  v_lshrrev_b32 v49, 9, v41
  v_and_b32 v49, s50, v49
  v_cmp_gt_u32 s[74:75], s51, v49
  v_lshrrev_b32 v50, 9, v42
  v_and_b32 v50, s50, v50
  v_cmp_gt_u32 s[76:77], s51, v50
  v_lshrrev_b32 v51, 9, v43
  v_and_b32 v51, s50, v51
  v_cmp_gt_u32 s[78:79], s51, v51
  s_mov_b64 s[64:65], 0
  s_mov_b64 s[66:67], 0
  s_mov_b64 s[68:69], 0
  s_mov_b64 s[70:71], 0
  s_branch K_resort
K_marks:
  s_mov_b32 s7, 3
  v_mov_b32 v84, 0
  v_bfe_u32 v85, v36, 14, 6
  v_cmp_eq_u32 vcc, 62, v85
  s_nop 1
  v_cndmask_b32 v84, v84, v36, vcc
  v_bfe_u32 v85, v37, 14, 6
  v_cmp_eq_u32 vcc, 62, v85
  s_nop 1
  v_cndmask_b32 v84, v84, v37, vcc
  v_bfe_u32 v85, v38, 14, 6
  v_cmp_eq_u32 vcc, 62, v85
  s_nop 1
  v_cndmask_b32 v84, v84, v38, vcc
  v_bfe_u32 v85, v39, 14, 6
  v_cmp_eq_u32 vcc, 62, v85
  s_nop 1
  v_cndmask_b32 v84, v84, v39, vcc
  v_bfe_u32 v85, v40, 14, 6
  v_cmp_eq_u32 vcc, 62, v85
  s_nop 1
  v_cndmask_b32 v84, v84, v40, vcc
  v_bfe_u32 v85, v41, 14, 6
  v_cmp_eq_u32 vcc, 62, v85
  s_nop 1
  v_cndmask_b32 v84, v84, v41, vcc
  v_bfe_u32 v85, v42, 14, 6
  v_cmp_eq_u32 vcc, 62, v85
  s_nop 1
  v_cndmask_b32 v84, v84, v42, vcc
  v_bfe_u32 v85, v43, 14, 6
  v_cmp_eq_u32 vcc, 62, v85
  s_nop 1
  v_cndmask_b32 v84, v84, v43, vcc
  s_nop 1
  v_or_b32_dpp v84, v84, v84 quad_perm:[1,0,3,2] row_mask:0xf bank_mask:0xf
  s_nop 1
  v_or_b32_dpp v84, v84, v84 quad_perm:[2,3,0,1] row_mask:0xf bank_mask:0xf
  v_cmp_ne_u32 vcc, 0, v84
  v_lshrrev_b32 v84, 20, v84
  v_add_lshl_u32 v84, v84, v203, 2
  s_mov_b32 s44, 8388608
  buffer_load_dword v201, v84, s[12:15], s44 offen sc1
  v_add_u32 v200, v84, v202
  s_mov_b32 s44, 8388548
  s_waitcnt vmcnt(0)
  v_cndmask_b32 v201, 0, v201, vcc
  v_min_u32 v201, 12512, v201
  v_add_u32 v201, 64, v201
K_next:
  s_add_u32 s44, s44, 64
  v_add_u32 v201, -64, v201
  buffer_load_dwordx4 v[36:39], v200, s[12:15], s44 offen sc1
  v_cmp_lt_i32 s[56:57], 64, v201
  v_sub_u32 v84, v201, v202
  v_cmp_lt_i32 s[64:65], 0, v84
  v_cmp_lt_i32 s[66:67], 4, v84
  v_cmp_lt_i32 s[68:69], 8, v84
  v_cmp_lt_i32 s[70:71], 12, v84
  s_mov_b64 s[72:73], 0
  s_mov_b64 s[74:75], 0
  s_mov_b64 s[76:77], 0
  s_mov_b64 s[78:79], 0
K_resort:
  s_mul_i32 s50, s36, 20480
  s_add_u32 s50, s50, 7168
  v_and_b32 v98, 32, v2
  v_bfe_u32 v97, v2, 4, 1
  v_bfe_u32 v96, v2, 3, 1
  v_lshl_add_u32 v96, v96, 2, v97
  v_add_u32 v96, v96, v98
  v_lshl_add_u32 v185, v96, 3, s50
  v_and_b32 v96, 0x2c, v2
  v_lshl_add_u32 v187, v96, 3, s50
  v_and_b32 v96, 2, v2
  v_bfe_u32 v99, v2, 2, 1
  v_lshl_add_u32 v96, v96, 1, v99
  v_and_or_b32 v96, v2, 8, v96
  s_lshr_b32 s51, s37, 1
  s_lshl_b32 s51, s51, 7
  s_add_u32 s50, s50, s51
  s_and_b32 s51, s37, 1
  s_lshl_b32 s51, s51, 8
  s_add_u32 s50, s50, s51
  v_lshl_add_u32 v186, v96, 3, s50
  v_mov_b32 v77, 8
  v_lshlrev_b32 v76, 5, v2
  v_mov_b32 v78, 0
  s_waitcnt vmcnt(0) lgkmcnt(0)
  s_barrier
  s_mov_b64 exec, s[56:57]
  ds_write_b32 v78, v77 offset:1984
  s_mov_b64 exec, -1
  s_movk_i32 s51, 2016
  s_movk_i32 s50, 2044
  v_lshrrev_b32 v44, 9, v36
  v_and_b32 v44, s50, v44
  v_lshrrev_b32 v45, 9, v37
  v_and_b32 v45, s50, v45
  v_lshrrev_b32 v46, 9, v38
  v_and_b32 v46, s50, v46
  v_lshrrev_b32 v47, 9, v39
  v_and_b32 v47, s50, v47
  v_lshrrev_b32 v48, 9, v40
  v_and_b32 v48, s50, v48
  v_lshrrev_b32 v49, 9, v41
  v_and_b32 v49, s50, v49
  v_lshrrev_b32 v50, 9, v42
  v_and_b32 v50, s50, v50
  v_lshrrev_b32 v51, 9, v43
  v_and_b32 v51, s50, v51
  s_mov_b64 exec, s[64:65]
  ds_add_rtn_u32 v52, v44, v77
  s_mov_b64 exec, s[66:67]
  ds_add_rtn_u32 v53, v45, v77
  s_mov_b64 exec, s[68:69]
  ds_add_rtn_u32 v54, v46, v77
  s_mov_b64 exec, s[70:71]
  ds_add_rtn_u32 v55, v47, v77
  s_mov_b64 exec, s[72:73]
  ds_add_rtn_u32 v56, v48, v77
  s_mov_b64 exec, s[74:75]
  ds_add_rtn_u32 v57, v49, v77
  s_mov_b64 exec, s[76:77]
  ds_add_rtn_u32 v58, v50, v77
  s_mov_b64 exec, s[78:79]
  ds_add_rtn_u32 v59, v51, v77
  s_mov_b64 exec, -1
  s_movk_i32 s50, 2304
  v_lshrrev_b32 v101, 20, v36
  v_add_lshl_u32 v101, v101, v203, 5
  v_lshrrev_b32 v103, 20, v37
  v_add_lshl_u32 v103, v103, v203, 5
  v_lshrrev_b32 v105, 20, v38
  v_add_lshl_u32 v105, v105, v203, 5
  v_lshrrev_b32 v107, 20, v39
  v_add_lshl_u32 v107, v107, v203, 5
  v_lshrrev_b32 v109, 20, v40
  v_add_lshl_u32 v109, v109, v203, 5
  v_lshrrev_b32 v111, 20, v41
  v_add_lshl_u32 v111, v111, v203, 5
  v_lshrrev_b32 v113, 20, v42
  v_add_lshl_u32 v113, v113, v203, 5
  v_lshrrev_b32 v115, 20, v43
  v_add_lshl_u32 v115, v115, v203, 5
  s_cmp_eq_u32 s3, 4
  s_waitcnt lgkmcnt(0)
  s_barrier
  s_cbranch_scc1 K_scanb
  v_and_b32 v100, 0x3fff, v36
  v_and_b32 v3, 0xfc000, v36
  v_mad_u32_u24 v100, v3, s50, v100
  v_and_b32 v102, 0x3fff, v37
  v_and_b32 v3, 0xfc000, v37
  v_mad_u32_u24 v102, v3, s50, v102
  v_and_b32 v104, 0x3fff, v38
  v_and_b32 v3, 0xfc000, v38
  v_mad_u32_u24 v104, v3, s50, v104
  v_and_b32 v106, 0x3fff, v39
  v_and_b32 v3, 0xfc000, v39
  v_mad_u32_u24 v106, v3, s50, v106
  v_and_b32 v108, 0x3fff, v40
  v_and_b32 v3, 0xfc000, v40
  v_mad_u32_u24 v108, v3, s50, v108
  v_and_b32 v110, 0x3fff, v41
  v_and_b32 v3, 0xfc000, v41
  v_mad_u32_u24 v110, v3, s50, v110
  v_and_b32 v112, 0x3fff, v42
  v_and_b32 v3, 0xfc000, v42
  v_mad_u32_u24 v112, v3, s50, v112
  v_and_b32 v114, 0x3fff, v43
  v_and_b32 v3, 0xfc000, v43
  v_mad_u32_u24 v114, v3, s50, v114
  s_branch K_scannedb
K_scanb:
  ds_read_b128 v[116:119], v76
  ds_read_b128 v[120:123], v76 offset:16
  s_setprio 1
  v_and_b32 v100, 0x3fff, v36
  v_and_b32 v3, 0xfc000, v36
  v_mad_u32_u24 v100, v3, s50, v100
  v_and_b32 v102, 0x3fff, v37
  v_and_b32 v3, 0xfc000, v37
  v_mad_u32_u24 v102, v3, s50, v102
  v_and_b32 v104, 0x3fff, v38
  v_and_b32 v3, 0xfc000, v38
  v_mad_u32_u24 v104, v3, s50, v104
  v_and_b32 v106, 0x3fff, v39
  v_and_b32 v3, 0xfc000, v39
  v_mad_u32_u24 v106, v3, s50, v106
  v_and_b32 v108, 0x3fff, v40
  v_and_b32 v3, 0xfc000, v40
  v_mad_u32_u24 v108, v3, s50, v108
  v_and_b32 v110, 0x3fff, v41
  v_and_b32 v3, 0xfc000, v41
  v_mad_u32_u24 v110, v3, s50, v110
  v_and_b32 v112, 0x3fff, v42
  v_and_b32 v3, 0xfc000, v42
  v_mad_u32_u24 v112, v3, s50, v112
  v_and_b32 v114, 0x3fff, v43
  v_and_b32 v3, 0xfc000, v43
  v_mad_u32_u24 v114, v3, s50, v114
  s_mov_b32 s51, 0xffe0ffe0
  s_waitcnt lgkmcnt(0)
  v_readlane_b32 s46, v116, 62
  v_writelane_b32 v116, 0, 62
  v_add_u32 v117, v116, v117
  v_add_u32 v118, v117, v118
  v_add_u32 v119, v118, v119
  v_add_u32 v120, v119, v120
  v_add_u32 v121, v120, v121
  v_add_u32 v122, v121, v122
  v_add_u32 v123, v122, v123
  v_add_u32 v60, 15, v123
  v_and_b32 v60, 0xffe0, v60
  v_mov_b32 v78, v60
  v_cmp_lt_u32 s[88:89], v60, v123
  v_lshl_or_b32 v125, v117, 16, v116
  v_lshl_or_b32 v127, v119, 16, v118
  v_lshl_or_b32 v129, v121, 16, v120
  v_lshl_or_b32 v131, v123, 16, v122
  v_mbcnt_lo_u32_b32 v61, s88, 0
  v_mbcnt_hi_u32_b32 v61, s89, v61
  v_sub_u32 v64, v123, v60
  v_mov_b32 v148, 0x1e001e00
  v_mov_b32 v149, 0x6e006e00
  v_readlane_b32 s56, v61, s43
  v_cmp_le_u32 vcc, s43, v2
  s_nop 0
  v_subrev_u32 v78, s56, v61
  v_cndmask_b32 v80, v148, v149, vcc
  v_cndmask_b32 v61, v61, v78, vcc
  v_cmp_gt_u32 s[56:57], 16, v61
  s_and_b64 s[88:89], s[88:89], s[56:57]
  v_lshl_add_u32 v61, v61, 5, v80
  v_cndmask_b32 v63, 0, 32, s[88:89]
  v_cndmask_b32 v64, 0, v64, s[88:89]
  v_sub_u32 v62, v63, v64
  v_lshl_or_b32 v62, v62, 16, v62
  v_add_u32 v125, v62, v125
  v_add_u32 v127, v62, v127
  v_add_u32 v129, v62, v129
  v_add_u32 v131, v62, v131
  v_add_u32 v132, 0x001f001f, v125
  v_add_u32 v133, 0x001f001f, v127
  v_add_u32 v134, 0x001f001f, v129
  v_add_u32 v135, 0x001f001f, v131
  v_and_b32 v132, s51, v132
  v_and_b32 v133, s51, v133
  v_and_b32 v134, s51, v134
  v_and_b32 v135, s51, v135
  v_lshl_or_b32 v136, v132, 16, v63
  v_alignbit_b32 v137, v133, v132, 16
  v_alignbit_b32 v138, v134, v133, 16
  v_alignbit_b32 v139, v135, v134, 16
  v_sub_u32 v140, v132, v136
  v_sub_u32 v141, v133, v137
  v_sub_u32 v142, v134, v138
  v_sub_u32 v143, v135, v139
  v_add_u32_dpp v140, v140, v140 row_shr:1 row_mask:0xf bank_mask:0xf
  v_add_u32_dpp v141, v141, v141 row_shr:1 row_mask:0xf bank_mask:0xf
  v_add_u32_dpp v142, v142, v142 row_shr:1 row_mask:0xf bank_mask:0xf
  v_add_u32_dpp v143, v143, v143 row_shr:1 row_mask:0xf bank_mask:0xf
  v_add_u32_dpp v140, v140, v140 row_shr:2 row_mask:0xf bank_mask:0xf
  v_add_u32_dpp v141, v141, v141 row_shr:2 row_mask:0xf bank_mask:0xf
  v_add_u32_dpp v142, v142, v142 row_shr:2 row_mask:0xf bank_mask:0xf
  v_add_u32_dpp v143, v143, v143 row_shr:2 row_mask:0xf bank_mask:0xf
  v_add_u32_dpp v140, v140, v140 row_shr:4 row_mask:0xf bank_mask:0xf
  v_add_u32_dpp v141, v141, v141 row_shr:4 row_mask:0xf bank_mask:0xf
  v_add_u32_dpp v142, v142, v142 row_shr:4 row_mask:0xf bank_mask:0xf
  v_add_u32_dpp v143, v143, v143 row_shr:4 row_mask:0xf bank_mask:0xf
  v_add_u32_dpp v140, v140, v140 row_shr:8 row_mask:0xf bank_mask:0xf
  v_add_u32_dpp v141, v141, v141 row_shr:8 row_mask:0xf bank_mask:0xf
  v_add_u32_dpp v142, v142, v142 row_shr:8 row_mask:0xf bank_mask:0xf
  v_add_u32_dpp v143, v143, v143 row_shr:8 row_mask:0xf bank_mask:0xf
  v_add_u32_dpp v140, v140, v140 row_bcast:15 row_mask:0xa bank_mask:0xf
  v_add_u32_dpp v141, v141, v141 row_bcast:15 row_mask:0xa bank_mask:0xf
  v_add_u32_dpp v142, v142, v142 row_bcast:15 row_mask:0xa bank_mask:0xf
  v_add_u32_dpp v143, v143, v143 row_bcast:15 row_mask:0xa bank_mask:0xf
  v_add_u32_dpp v140, v140, v140 row_bcast:31 row_mask:0xc bank_mask:0xf
  v_add_u32_dpp v141, v141, v141 row_bcast:31 row_mask:0xc bank_mask:0xf
  v_add_u32_dpp v142, v142, v142 row_bcast:31 row_mask:0xc bank_mask:0xf
  v_add_u32_dpp v143, v143, v143 row_bcast:31 row_mask:0xc bank_mask:0xf
  v_sub_u32 v136, v132, v136
  v_sub_u32 v137, v133, v137
  v_sub_u32 v138, v134, v138
  v_sub_u32 v139, v135, v139
  v_sub_u32 v144, v140, v136
  v_sub_u32 v145, v141, v137
  v_sub_u32 v146, v142, v138
  v_sub_u32 v147, v143, v139
  v_readlane_b32 s84, v140, 63
  v_readlane_b32 s85, v141, 63
  v_readlane_b32 s86, v142, 63
  v_readlane_b32 s87, v143, 63
  v_readlane_b32 s80, v144, s43
  v_readlane_b32 s81, v145, s43
  v_readlane_b32 s82, v146, s43
  v_readlane_b32 s83, v147, s43
  v_sub_u32 v125, v132, v125
  v_sub_u32 v127, v133, v127
  v_sub_u32 v129, v134, v129
  v_sub_u32 v131, v135, v131
  v_mov_b32 v148, s80
  v_mov_b32 v149, s81
  v_mov_b32 v150, s82
  v_mov_b32 v151, s83
  v_sub_u32 v152, s84, v148
  v_cndmask_b32 v132, 0, v148, vcc
  v_sub_u32 v153, s85, v149
  v_cndmask_b32 v133, 0, v149, vcc
  v_sub_u32 v154, s86, v150
  v_cndmask_b32 v134, 0, v150, vcc
  v_sub_u32 v155, s87, v151
  v_cndmask_b32 v135, 0, v151, vcc
  v_cndmask_b32 v148, v148, v152, vcc
  v_cndmask_b32 v149, v149, v153, vcc
  v_cndmask_b32 v150, v150, v154, vcc
  v_cndmask_b32 v151, v151, v155, vcc
  v_add_u32 v61, 4294966816, v61
  s_mov_b32 s51, 0x03020302
  v_lshl_or_b32 v124, v125, 16, v64
  v_sub_u32 v144, v144, v132
  v_alignbit_b32 v126, v127, v125, 16
  v_sub_u32 v145, v145, v133
  v_alignbit_b32 v128, v129, v127, 16
  v_sub_u32 v146, v146, v134
  v_alignbit_b32 v130, v131, v129, 16
  v_sub_u32 v147, v147, v135
  ds_write_b128 v76, v[124:127] offset:4096
  ds_write_b128 v76, v[128:131] offset:4112
  v_lshl_add_u32 v78, v148, 16, v80
  v_pk_min_u16 v152, v136, 1 op_sel_hi:[1,0]
  v_add_u32 v79, v78, v148
  v_add_u32 v144, v144, v78
  v_perm_b32 v80, v79, v79, s51
  v_lshl_add_u32 v78, v149, 16, v80
  v_pk_min_u16 v153, v137, 1 op_sel_hi:[1,0]
  v_add_u32 v79, v78, v149
  v_add_u32 v145, v145, v78
  v_perm_b32 v80, v79, v79, s51
  v_lshl_add_u32 v78, v150, 16, v80
  v_pk_min_u16 v154, v138, 1 op_sel_hi:[1,0]
  v_add_u32 v79, v78, v150
  v_add_u32 v146, v146, v78
  v_perm_b32 v80, v79, v79, s51
  v_lshl_add_u32 v78, v151, 16, v80
  v_pk_min_u16 v155, v139, 1 op_sel_hi:[1,0]
  v_add_u32 v79, v78, v151
  v_add_u32 v147, v147, v78
  v_perm_b32 v80, v79, v79, s51
  v_add_u32 v140, v144, v136
  v_sub_u32 v116, v144, v124
  v_add_u32 v141, v145, v137
  v_sub_u32 v118, v145, v126
  v_add_u32 v142, v146, v138
  v_sub_u32 v120, v146, v128
  v_add_u32 v143, v147, v139
  v_sub_u32 v122, v147, v130
  v_readlane_b32 s56, v80, 0
  v_readlane_b32 s57, v80, 63
  v_pk_mul_lo_u16 v152, v152, v140
  v_lshrrev_b32 v117, 16, v116
  v_pk_mul_lo_u16 v153, v153, v141
  v_lshrrev_b32 v119, 16, v118
  v_pk_mul_lo_u16 v154, v154, v142
  v_lshrrev_b32 v121, 16, v120
  v_pk_mul_lo_u16 v155, v155, v143
  v_lshrrev_b32 v123, 16, v122
  v_and_b32 v78, 0xffff, v61
  v_cndmask_b32 v78, 0, v78, s[88:89]
  s_movk_i32 s51, 6144
  v_sub_u16_sdwa v116, v78, v124 dst_sel:WORD_1 dst_unused:UNUSED_PRESERVE src0_sel:WORD_0 src1_sel:WORD_0
  v_max_u32_sdwa v78, v78, v152 dst_sel:DWORD dst_unused:UNUSED_PAD src0_sel:DWORD src1_sel:WORD_0
  v_sub_u16_sdwa v117, v78, v125 dst_sel:WORD_1 dst_unused:UNUSED_PRESERVE src0_sel:WORD_0 src1_sel:WORD_0
  v_max_u32_sdwa v78, v78, v152 dst_sel:DWORD dst_unused:UNUSED_PAD src0_sel:DWORD src1_sel:WORD_1
  v_sub_u16_sdwa v118, v78, v126 dst_sel:WORD_1 dst_unused:UNUSED_PRESERVE src0_sel:WORD_0 src1_sel:WORD_0
  v_max_u32_sdwa v78, v78, v153 dst_sel:DWORD dst_unused:UNUSED_PAD src0_sel:DWORD src1_sel:WORD_0
  v_sub_u16_sdwa v119, v78, v127 dst_sel:WORD_1 dst_unused:UNUSED_PRESERVE src0_sel:WORD_0 src1_sel:WORD_0
  v_max_u32_sdwa v78, v78, v153 dst_sel:DWORD dst_unused:UNUSED_PAD src0_sel:DWORD src1_sel:WORD_1
  v_sub_u16_sdwa v120, v78, v128 dst_sel:WORD_1 dst_unused:UNUSED_PRESERVE src0_sel:WORD_0 src1_sel:WORD_0
  v_max_u32_sdwa v78, v78, v154 dst_sel:DWORD dst_unused:UNUSED_PAD src0_sel:DWORD src1_sel:WORD_0
  v_sub_u16_sdwa v121, v78, v129 dst_sel:WORD_1 dst_unused:UNUSED_PRESERVE src0_sel:WORD_0 src1_sel:WORD_0
  v_max_u32_sdwa v78, v78, v154 dst_sel:DWORD dst_unused:UNUSED_PAD src0_sel:DWORD src1_sel:WORD_1
  v_sub_u16_sdwa v122, v78, v130 dst_sel:WORD_1 dst_unused:UNUSED_PRESERVE src0_sel:WORD_0 src1_sel:WORD_0
  v_max_u32_sdwa v78, v78, v155 dst_sel:DWORD dst_unused:UNUSED_PAD src0_sel:DWORD src1_sel:WORD_0
  v_sub_u16_sdwa v123, v78, v131 dst_sel:WORD_1 dst_unused:UNUSED_PRESERVE src0_sel:WORD_0 src1_sel:WORD_0
  v_writelane_b32 v116, s51, 62
  ds_write_b128 v76, v[116:119] offset:2048
  ds_write_b128 v76, v[120:123] offset:2064
  s_pack_hh_b32_b16 s50, s56, s57
  s_sub_u32 s50, s50, 0x6b011b01
  v_mov_b32 v152, s50
  v_mov_b32 v153, s43
  v_mov_b32 v154, s46
  ds_write_b96 v77, v[152:154] offset:2008
  s_setprio 0
  s_waitcnt lgkmcnt(0)
K_scannedb:
  s_cmp_lg_u32 s3, 4
  s_barrier
  ds_read_b96 v[152:154], v77 offset:2008
  ds_read2st64_b32 v[60:61], v44 offset0:8 offset1:16
  ds_read2st64_b32 v[62:63], v45 offset0:8 offset1:16
  ds_read2st64_b32 v[64:65], v46 offset0:8 offset1:16
  ds_read2st64_b32 v[66:67], v47 offset0:8 offset1:16
  ds_read2st64_b32 v[68:69], v48 offset0:8 offset1:16
  ds_read2st64_b32 v[70:71], v49 offset0:8 offset1:16
  ds_read2st64_b32 v[72:73], v50 offset0:8 offset1:16
  ds_read2st64_b32 v[74:75], v51 offset0:8 offset1:16
  s_cbranch_scc1 K_restb
K_restb:
  s_waitcnt lgkmcnt(8)
  v_readfirstlane_b32 s50, v152
  v_readfirstlane_b32 s43, v153
  v_readfirstlane_b32 s46, v154
  s_bfe_u32 s56, s50, 0x80008
  s_lshr_b32 s57, s50, 24
  s_max_u32 s57, s57, 1
  s_max_u32 s58, s56, s57
  s_cmp_le_u32 s58, 72
  s_cbranch_scc0 K_over
  s_sub_u32 s59, s58, 1
  s_max_u32 s59, s59, s57
  s_add_u32 s56, s58, 1
  s_and_b32 s56, s56, -2
  s_cmp_lt_u32 s58, 9
  s_cselect_b32 s58, s56, s58
  s_cselect_b32 s59, s56, s59
  s_sub_u32 s61, s58, s59
  s_cmp_eq_u32 s36, 0
  s_cselect_b32 s41, s58, s59
  s_waitcnt lgkmcnt(4)
  v_cmp_lt_u32_sdwa s[80:81], v52, v61 src0_sel:DWORD src1_sel:WORD_0
  v_lshrrev_b32 v61, 16, v60
  v_cmp_lt_u32_sdwa s[82:83], v53, v63 src0_sel:DWORD src1_sel:WORD_0
  v_lshrrev_b32 v63, 16, v62
  v_cmp_lt_u32_sdwa s[84:85], v54, v65 src0_sel:DWORD src1_sel:WORD_0
  v_lshrrev_b32 v65, 16, v64
  v_cmp_lt_u32_sdwa s[86:87], v55, v67 src0_sel:DWORD src1_sel:WORD_0
  v_lshrrev_b32 v67, 16, v66
  v_cndmask_b32 v60, v60, v61, s[80:81]
  v_add_u32_sdwa v52, v52, v60 dst_sel:DWORD dst_unused:UNUSED_PAD src0_sel:DWORD src1_sel:WORD_0
  v_cndmask_b32 v62, v62, v63, s[82:83]
  v_add_u32_sdwa v53, v53, v62 dst_sel:DWORD dst_unused:UNUSED_PAD src0_sel:DWORD src1_sel:WORD_0
  v_cndmask_b32 v64, v64, v65, s[84:85]
  v_add_u32_sdwa v54, v54, v64 dst_sel:DWORD dst_unused:UNUSED_PAD src0_sel:DWORD src1_sel:WORD_0
  v_cndmask_b32 v66, v66, v67, s[86:87]
  v_add_u32_sdwa v55, v55, v66 dst_sel:DWORD dst_unused:UNUSED_PAD src0_sel:DWORD src1_sel:WORD_0
  s_waitcnt lgkmcnt(0)
  v_cmp_lt_u32_sdwa s[80:81], v56, v69 src0_sel:DWORD src1_sel:WORD_0
  v_lshrrev_b32 v69, 16, v68
  v_cmp_lt_u32_sdwa s[82:83], v57, v71 src0_sel:DWORD src1_sel:WORD_0
  v_lshrrev_b32 v71, 16, v70
  v_cmp_lt_u32_sdwa s[84:85], v58, v73 src0_sel:DWORD src1_sel:WORD_0
  v_lshrrev_b32 v73, 16, v72
  v_cmp_lt_u32_sdwa s[86:87], v59, v75 src0_sel:DWORD src1_sel:WORD_0
  v_lshrrev_b32 v75, 16, v74
  v_cndmask_b32 v68, v68, v69, s[80:81]
  v_add_u32_sdwa v56, v56, v68 dst_sel:DWORD dst_unused:UNUSED_PAD src0_sel:DWORD src1_sel:WORD_0
  v_cndmask_b32 v70, v70, v71, s[82:83]
  v_add_u32_sdwa v57, v57, v70 dst_sel:DWORD dst_unused:UNUSED_PAD src0_sel:DWORD src1_sel:WORD_0
  v_cndmask_b32 v72, v72, v73, s[84:85]
  v_add_u32_sdwa v58, v58, v72 dst_sel:DWORD dst_unused:UNUSED_PAD src0_sel:DWORD src1_sel:WORD_0
  v_cndmask_b32 v74, v74, v75, s[86:87]
  v_add_u32_sdwa v59, v59, v74 dst_sel:DWORD dst_unused:UNUSED_PAD src0_sel:DWORD src1_sel:WORD_0
  s_mov_b64 exec, s[64:65]
  ds_write_b64 v52, v[100:101]
  s_mov_b64 exec, s[66:67]
  ds_write_b64 v53, v[102:103]
  s_mov_b64 exec, s[68:69]
  ds_write_b64 v54, v[104:105]
  s_mov_b64 exec, s[70:71]
  ds_write_b64 v55, v[106:107]
  s_mov_b64 exec, s[72:73]
  ds_write_b64 v56, v[108:109]
  s_mov_b64 exec, s[74:75]
  ds_write_b64 v57, v[110:111]
  s_mov_b64 exec, s[76:77]
  ds_write_b64 v58, v[112:113]
  s_mov_b64 exec, s[78:79]
  ds_write_b64 v59, v[114:115]
  s_mov_b64 exec, -1
  s_cmp_eq_u32 s7, 2
  s_cselect_b32 s46, s9, s46
  s_cmp_eq_u32 s7, 1
  s_cselect_b32 s46, 1, s46
  s_cbranch_scc1 K_sorted
  s_waitcnt lgkmcnt(0)
  s_barrier
  s_sub_u32 s24, s4, 3072
  s_subb_u32 s25, s5, 0
  s_mov_b32 s26, s14
  ds_read_b32 v178, v186 offset:20
  ds_read_b32 v1, v186 offset:516
  ds_read2_b32 v[104:105], v185 offset0:4 offset1:20
  ds_read2_b32 v[106:107], v185 offset0:36 offset1:52
  ds_read2_b32 v[188:189], v187 offset0:6 offset1:38
  s_waitcnt lgkmcnt(0)
  s_add_u32 m0, s40, 1024
  s_mov_b64 exec, 0xffff
  v_or_b32 v178, v178, v179
  buffer_load_dwordx4 v178, s[16:19], 0 offen  lds
  s_mov_b64 exec, -1
  s_add_u32 m0, s40, 2048
  s_mov_b64 exec, 0xffff
  v_or_b32 v1, v1, v179
  buffer_load_dwordx4 v1, s[16:19], 0 offen  lds
  s_mov_b64 exec, -1
  s_add_u32 m0, s39, 4096
  v_mad_u32_u16 v172, v104, s47, v207
  buffer_load_dwordx4 v172, s[24:27], 0 offen offset:0 sc1 lds
  v_mad_u32_u16 v173, v105, s47, v182
  buffer_load_dwordx4 v173, s[24:27], 0 offen offset:1024 sc1 lds
  v_mad_u32_u16 v174, v106, s47, v177
  buffer_load_dwordx4 v174, s[24:27], 0 offen offset:2048 sc1 lds
  v_mad_u32_u16 v175, v107, s47, v176
  buffer_load_dwordx4 v175, s[24:27], 0 offen offset:3072 sc1 lds
  ds_read_b32 v178, v186 offset:532
  ds_read2_b32 v[104:105], v185 offset0:128 offset1:144
  ds_read2_b32 v[106:107], v185 offset0:160 offset1:176
  v_add_u32_sdwa v188, v188, v190 dst_sel:DWORD dst_unused:UNUSED_PAD src0_sel:WORD_1 src1_sel:DWORD
  v_add_u32_sdwa v189, v189, v190 dst_sel:DWORD dst_unused:UNUSED_PAD src0_sel:WORD_1 src1_sel:DWORD
  s_branch K_fillb
K_over:
  s_cmp_lg_u32 s7, 0
  s_cbranch_scc1 K_end
  s_mov_b32 s7, 1
  s_mov_b32 s9, s46
  s_mov_b64 s[56:57], 0
  s_waitcnt lgkmcnt(0)
  s_barrier
  v_lshlrev_b32 v76, 2, v0
  v_mov_b32 v77, 0
  ds_write_b32 v76, v77
  s_mov_b64 s[72:73], 0
  s_mov_b64 s[74:75], 0
  s_mov_b64 s[76:77], 0
  s_mov_b64 s[78:79], 0
  s_branch K_resort
K_codeend:
.section .rodata,"a"
.p2align 6
.amdhsa_kernel gather_scatter__edge_featured_mpnn_gatedgcn__graph_kernel
  .amdhsa_next_free_vgpr 256
  .amdhsa_next_free_sgpr 100
  .amdhsa_accum_offset 256
  .amdhsa_group_segment_fixed_size 0
  .amdhsa_kernarg_size 96
  .amdhsa_user_sgpr_count 2
  .amdhsa_user_sgpr_kernarg_segment_ptr 1
  .amdhsa_system_sgpr_workgroup_id_x 1
.end_amdhsa_kernel
.text
```
